```python
import torch

def _softmax(x, axis=-1):
    return torch.softmax(x, dim=axis)

def _gelu(x):
    return torch.nn.functional.gelu(x, approximate='tanh')

def _silu(x):
    return torch.nn.functional.silu(x)

def _sigmoid(x):
    return torch.sigmoid(x)

def _layernorm(x, axis=-1, eps=1e-05):
    m = x.mean(dim=axis, keepdim=True)
    v = x.var(dim=axis, keepdim=True, unbiased=False)
    return (x - m) / torch.sqrt(v + eps)

def _scatter_add(tgt, idx, src, axis=0):
    return tgt.clone().index_add_(axis, idx, src)

def _segment_sum(src, seg, n):
    out = torch.zeros((n,) + src.shape[1:], dtype=src.dtype)
    return out.index_add_(0, seg, src)

def _pad(x, pw):
    flat = tuple((v for pair in reversed(pw) for v in pair))
    return torch.nn.functional.pad(x, flat)
kernel_name = 'adaLN_cond__gqa_block_cached__dense_activation_relu__decode'

def setup_inputs():

    _w = lambda a: (lambda t: t.to(torch.bfloat16) if t.is_floating_point() else t)(torch.as_tensor(a))

    def _A_setup():
        B, Sq, D = (1, 1, 512)
        Hq, Hkv, Sk, Dh = (32, 32, 8192, 128)
        assert Hq % Hkv == 0, (Hq, Hkv)
        return {'x': _w((lambda *s: torch.randn(*s, dtype=torch.bfloat16) * 0.1)(B, Sq, D)), 'k_cache': _w((lambda *s: torch.randn(*s, dtype=torch.bfloat16) * 0.8)(B, Hkv, Sk, Dh)), 'v_cache': _w((lambda *s: torch.randn(*s, dtype=torch.bfloat16) * 0.8)(B, Hkv, Sk, Dh)), 'wq': _w((lambda *s: torch.randn(*s, dtype=torch.bfloat16) * 0.8)(D, Hq * Dh) * D ** (-0.5)), 'wo': _w((lambda *s: torch.randn(*s, dtype=torch.bfloat16) * 0.8)(Hq * Dh, D) * (Hq * Dh) ** (-0.5))}
    _A_in = _A_setup()

    def _B_setup():
        B, S, D, Dff = (1, 1, 512, 1376)
        return {'x': _w((lambda *s: torch.randn(*s, dtype=torch.bfloat16) * 0.1)(B, S, D)), 'w1': _w((lambda *s: torch.randn(*s, dtype=torch.bfloat16) * 0.1)(D, Dff)), 'w2': _w((lambda *s: torch.randn(*s, dtype=torch.bfloat16) * 0.1)(Dff, D))}
    _B_in = _B_setup()
    return {'A_x': _A_in['x'], 'A_k_cache': _A_in['k_cache'], 'A_v_cache': _A_in['v_cache'], 'A_wq': _A_in['wq'], 'A_wo': _A_in['wo'], 'B_x': _B_in['x'], 'B_w1': _B_in['w1'], 'B_w2': _B_in['w2'], 'c': _w((lambda *s: torch.randn(*s, dtype=torch.bfloat16) * 0.4)(1, 512) * 8.0), 'w_mod': _w((lambda *s: torch.randn(*s, dtype=torch.bfloat16) * 0.4)(512, 6 * 512) * 512 ** (-0.5) * 8.0)}

def reference(A_x, A_k_cache, A_v_cache, A_wq, A_wo, B_x, B_w1, B_w2, c, w_mod):

    def _A_ref(x, k_cache, v_cache, wq, wo):
        B, Sq, D = x.shape
        Hq, Dh = (32, 128)
        Hkv = k_cache.shape[1]
        rep = Hq // Hkv
        q = (lambda x, *d: x.permute(*d))((x @ wq).reshape(B, Sq, Hq, Dh), 0, 2, 1, 3)
        k = (lambda x, n, axis: torch.repeat_interleave(x, n, dim=axis))(k_cache, rep, axis=1)
        v = (lambda x, n, axis: torch.repeat_interleave(x, n, dim=axis))(v_cache, rep, axis=1)
        scores = torch.einsum('bhqd,bhkd->bhqk', q, k) * Dh ** (-0.5)
        p = _softmax(scores, axis=-1)
        o = torch.einsum('bhqk,bhkd->bhqd', p, v)
        return (lambda x, *d: x.permute(*d))(o, 0, 2, 1, 3).reshape(B, Sq, Hq * Dh) @ wo

    def _B_ref(x, w1, w2):
        h = torch.einsum('bsd,df->bsf', x, w1)
        zero = torch.zeros_like(h)
        h = torch.maximum(h, zero)
        return torch.einsum('bsf,fd->bsd', h, w2)
    x = A_x
    mod = (_silu(c) @ w_mod).reshape(c.shape[0], 6, 1, -1)
    sa, ca, ga, sb, cb, gb = (mod[:, 0].clone(), mod[:, 1].clone(), mod[:, 2].clone(), mod[:, 3].clone(), mod[:, 4].clone(), mod[:, 5].clone())
    h = _layernorm(x, axis=-1) * (1 + ca) + sa
    x = x + ga * _A_ref(h, A_k_cache, A_v_cache, A_wq, A_wo)
    h = _layernorm(x, axis=-1) * (1 + cb) + sb
    x = x + gb * _B_ref(h, B_w1, B_w2)
    return x
```

```asm
; @launch grid=(256,1,1) block=(256,1,1) lds=16896
.amdgcn_target "amdgcn-amd-amdhsa--gfx950"
.text
.globl adaLN_cond__gqa_block_cached__dense_activation_relu__decode_kernel
.p2align 8
.type adaLN_cond__gqa_block_cached__dense_activation_relu__decode_kernel,@function
adaLN_cond__gqa_block_cached__dense_activation_relu__decode_kernel:
    s_and_b32 s5, s2, 7
    s_cmp_eq_u32 s5, 0
    s_cbranch_scc1 L_leader
    s_cmp_ge_u32 s2, 32
    s_cbranch_scc1 L_nopf_1
    v_lshlrev_b32 v2, 7, v0
    s_getpc_b64 s[8:9]
L_pf_w:
    v_min_u32 v2, L_leader-L_pf_w, v2
    global_load_dword v50, v2, s[8:9]
L_nopf_1:
    s_load_dwordx2 s[44:45], s[0:1], 8
    s_load_dwordx2 s[48:49], s[0:1], 16
    s_load_dwordx2 s[52:53], s[0:1], 96
    s_cmp_ge_u32 s2, 256
    s_cbranch_scc1 L_exit
    v_lshrrev_b32 v1, 6, v0
    s_lshr_b32 s4, s2, 3
    s_mov_b32 s46, 67108864
    v_readfirstlane_b32 s3, v1
    v_and_b32 v4, 63, v0
    v_lshlrev_b32 v0, 4, v4
    s_mov_b32 s47, 0x20000
    s_mov_b32 s50, 67108864
    s_mov_b32 s51, 0x20000
    s_sub_u32 s5, s5, 1
    s_mul_i32 s6, s3, 7
    s_add_u32 s5, s6, s5
    s_lshl_b32 s7, s4, 21
    s_mul_i32 s6, s5, 4096
    s_add_u32 s7, s7, s6
    s_waitcnt lgkmcnt(0)
    s_add_u32 s8, s7, 0
    buffer_load_dwordx4 v[64:67], v0, s[44:47], s8 offen offset:0 nt
    buffer_load_dwordx4 v[68:71], v0, s[44:47], s8 offen offset:1024 nt
    buffer_load_dwordx4 v[72:75], v0, s[44:47], s8 offen offset:2048 nt
    buffer_load_dwordx4 v[76:79], v0, s[44:47], s8 offen offset:3072 nt
    buffer_load_dwordx4 a[0:3], v0, s[48:51], s8 offen offset:0 nt
    buffer_load_dwordx4 a[4:7], v0, s[48:51], s8 offen offset:1024 nt
    buffer_load_dwordx4 a[8:11], v0, s[48:51], s8 offen offset:2048 nt
    buffer_load_dwordx4 a[12:15], v0, s[48:51], s8 offen offset:3072 nt
    s_add_u32 s8, s7, 114688
    buffer_load_dwordx4 v[80:83], v0, s[44:47], s8 offen offset:0 nt
    buffer_load_dwordx4 v[84:87], v0, s[44:47], s8 offen offset:1024 nt
    buffer_load_dwordx4 v[88:91], v0, s[44:47], s8 offen offset:2048 nt
    buffer_load_dwordx4 v[92:95], v0, s[44:47], s8 offen offset:3072 nt
    buffer_load_dwordx4 a[16:19], v0, s[48:51], s8 offen offset:0 nt
    buffer_load_dwordx4 a[20:23], v0, s[48:51], s8 offen offset:1024 nt
    buffer_load_dwordx4 a[24:27], v0, s[48:51], s8 offen offset:2048 nt
    buffer_load_dwordx4 a[28:31], v0, s[48:51], s8 offen offset:3072 nt
    s_mov_b32 s54, 268435456
    s_mov_b32 s55, 0x20000
    v_mov_b32 v5, 0
    buffer_load_dword v49, v5, s[52:55], 0 offen sc1
    s_cmp_lt_u32 s5, 8
    s_cselect_b32 s6, 19, 18
    s_lshl_b32 s14, s4, 21
    s_lshl_b32 s11, s5, 12
    s_add_u32 s14, s14, s11
    s_add_u32 s14, s14, 2064384
    s_nop 0
    v_and_b32 v4, 15, v4
    v_lshlrev_b32 v1, 5, v4
    s_lshl_b32 s9, s4, 9
    s_add_u32 s9, s9, 20480
    s_mov_b32 s42, 0x40000
    v_and_b32 v36, 7, v4
    v_lshrrev_b32 v37, 1, v36
    v_and_b32 v36, 1, v36
    v_mov_b32 v38, 0xffff
    v_mov_b32 v27, 0xffff0000
    v_cmp_eq_u32 vcc, 1, v36
    s_nop 1
    v_cndmask_b32 v36, v38, v27, vcc
    v_cmp_eq_u32 vcc, 0, v37
    s_nop 1
    v_cndmask_b32 v8, 0, v36, vcc
    v_cmp_eq_u32 vcc, 1, v37
    s_nop 1
    v_cndmask_b32 v9, 0, v36, vcc
    v_cmp_eq_u32 vcc, 2, v37
    s_nop 1
    v_cndmask_b32 v10, 0, v36, vcc
    v_cmp_eq_u32 vcc, 3, v37
    s_nop 1
    v_cndmask_b32 v11, 0, v36, vcc
    s_add_u32 s8, s7, 229376
    s_waitcnt vmcnt(15)
    buffer_load_dwordx4 v[96:99], v0, s[44:47], s8 offen offset:0 nt
    s_waitcnt vmcnt(15)
    buffer_load_dwordx4 v[100:103], v0, s[44:47], s8 offen offset:1024 nt
    s_waitcnt vmcnt(15)
    buffer_load_dwordx4 v[104:107], v0, s[44:47], s8 offen offset:2048 nt
    s_waitcnt vmcnt(15)
    buffer_load_dwordx4 v[108:111], v0, s[44:47], s8 offen offset:3072 nt
    s_waitcnt vmcnt(15)
    buffer_load_dwordx4 a[32:35], v0, s[48:51], s8 offen offset:0 nt
    s_waitcnt vmcnt(15)
    buffer_load_dwordx4 a[36:39], v0, s[48:51], s8 offen offset:1024 nt
    s_waitcnt vmcnt(15)
    buffer_load_dwordx4 a[40:43], v0, s[48:51], s8 offen offset:2048 nt
    s_waitcnt vmcnt(15)
    buffer_load_dwordx4 a[44:47], v0, s[48:51], s8 offen offset:3072 nt
    s_add_u32 s8, s7, 344064
    s_waitcnt vmcnt(15)
    buffer_load_dwordx4 v[112:115], v0, s[44:47], s8 offen offset:0 nt
    s_waitcnt vmcnt(15)
    buffer_load_dwordx4 v[116:119], v0, s[44:47], s8 offen offset:1024 nt
    s_waitcnt vmcnt(15)
    buffer_load_dwordx4 v[120:123], v0, s[44:47], s8 offen offset:2048 nt
    s_waitcnt vmcnt(15)
    buffer_load_dwordx4 v[124:127], v0, s[44:47], s8 offen offset:3072 nt
    s_waitcnt vmcnt(15)
    buffer_load_dwordx4 a[48:51], v0, s[48:51], s8 offen offset:0 nt
    s_waitcnt vmcnt(15)
    buffer_load_dwordx4 a[52:55], v0, s[48:51], s8 offen offset:1024 nt
    s_waitcnt vmcnt(15)
    buffer_load_dwordx4 a[56:59], v0, s[48:51], s8 offen offset:2048 nt
    s_waitcnt vmcnt(15)
    buffer_load_dwordx4 a[60:63], v0, s[48:51], s8 offen offset:3072 nt
    s_waitcnt vmcnt(16)
    s_mov_b32 s11, 2654435761
    v_mul_lo_u32 v3, v49, s11
    v_add_u32 v3, 2135587861, v3
    s_waitcnt vmcnt(15)
    buffer_load_dwordx4 v[40:43], v1, s[52:55], s9 offen sc1
    s_waitcnt vmcnt(15)
    buffer_load_dwordx4 v[44:47], v1, s[52:55], s9 offen offset:16 sc1
    s_add_u32 s8, s7, 458752
    s_waitcnt vmcnt(15)
    buffer_load_dwordx4 v[128:131], v0, s[44:47], s8 offen offset:0 nt
    s_waitcnt vmcnt(15)
    buffer_load_dwordx4 v[132:135], v0, s[44:47], s8 offen offset:1024 nt
    s_waitcnt vmcnt(15)
    buffer_load_dwordx4 v[136:139], v0, s[44:47], s8 offen offset:2048 nt
    s_waitcnt vmcnt(15)
    buffer_load_dwordx4 v[140:143], v0, s[44:47], s8 offen offset:3072 nt
    s_waitcnt vmcnt(15)
    buffer_load_dwordx4 a[64:67], v0, s[48:51], s8 offen offset:0 nt
    s_waitcnt vmcnt(15)
    buffer_load_dwordx4 a[68:71], v0, s[48:51], s8 offen offset:1024 nt
    s_waitcnt vmcnt(15)
    buffer_load_dwordx4 a[72:75], v0, s[48:51], s8 offen offset:2048 nt
    s_waitcnt vmcnt(15)
    buffer_load_dwordx4 a[76:79], v0, s[48:51], s8 offen offset:3072 nt
    s_waitcnt vmcnt(8)
    v_xor_b32 v36, v41, v3
    v_xor_b32 v37, v43, v3
    v_xor_b32 v38, v45, v3
    v_or3_b32 v36, v36, v37, v38
    v_xor_b32 v37, v47, v3
    v_or_b32 v36, v36, v37
    v_cmp_ne_u32 vcc, 0, v36
    s_cbranch_vccnz L_pf_2
    v_mov_b32 v4, v40
    v_mov_b32 v5, v42
    v_mov_b32 v6, v44
    v_mov_b32 v7, v46
    s_branch L_fast_5
L_pf_2:
    s_waitcnt vmcnt(15)
    buffer_load_dwordx4 v[40:43], v1, s[52:55], s9 offen sc1
    s_waitcnt vmcnt(15)
    buffer_load_dwordx4 v[44:47], v1, s[52:55], s9 offen offset:16 sc1
    s_add_u32 s8, s7, 573440
    s_waitcnt vmcnt(15)
    buffer_load_dwordx4 v[144:147], v0, s[44:47], s8 offen offset:0 nt
    s_waitcnt vmcnt(15)
    buffer_load_dwordx4 v[148:151], v0, s[44:47], s8 offen offset:1024 nt
    s_waitcnt vmcnt(15)
    buffer_load_dwordx4 v[152:155], v0, s[44:47], s8 offen offset:2048 nt
    s_waitcnt vmcnt(15)
    buffer_load_dwordx4 v[156:159], v0, s[44:47], s8 offen offset:3072 nt
    s_waitcnt vmcnt(15)
    buffer_load_dwordx4 a[80:83], v0, s[48:51], s8 offen offset:0 nt
    s_waitcnt vmcnt(15)
    buffer_load_dwordx4 a[84:87], v0, s[48:51], s8 offen offset:1024 nt
    s_waitcnt vmcnt(15)
    buffer_load_dwordx4 a[88:91], v0, s[48:51], s8 offen offset:2048 nt
    s_waitcnt vmcnt(15)
    buffer_load_dwordx4 a[92:95], v0, s[48:51], s8 offen offset:3072 nt
    s_waitcnt vmcnt(8)
    v_xor_b32 v36, v41, v3
    v_xor_b32 v37, v43, v3
    v_xor_b32 v38, v45, v3
    v_or3_b32 v36, v36, v37, v38
    v_xor_b32 v37, v47, v3
    v_or_b32 v36, v36, v37
    v_cmp_ne_u32 vcc, 0, v36
    s_cbranch_vccnz L_pf_3
    v_mov_b32 v4, v40
    v_mov_b32 v5, v42
    v_mov_b32 v6, v44
    v_mov_b32 v7, v46
    s_branch L_fast_6
L_pf_3:
    s_waitcnt vmcnt(15)
    buffer_load_dwordx4 v[40:43], v1, s[52:55], s9 offen sc1
    s_waitcnt vmcnt(15)
    buffer_load_dwordx4 v[44:47], v1, s[52:55], s9 offen offset:16 sc1
    s_add_u32 s8, s7, 688128
    s_waitcnt vmcnt(15)
    buffer_load_dwordx4 v[160:163], v0, s[44:47], s8 offen offset:0 nt
    s_waitcnt vmcnt(15)
    buffer_load_dwordx4 v[164:167], v0, s[44:47], s8 offen offset:1024 nt
    s_waitcnt vmcnt(15)
    buffer_load_dwordx4 v[168:171], v0, s[44:47], s8 offen offset:2048 nt
    s_waitcnt vmcnt(15)
    buffer_load_dwordx4 v[172:175], v0, s[44:47], s8 offen offset:3072 nt
    s_waitcnt vmcnt(15)
    buffer_load_dwordx4 a[96:99], v0, s[48:51], s8 offen offset:0 nt
    s_waitcnt vmcnt(15)
    buffer_load_dwordx4 a[100:103], v0, s[48:51], s8 offen offset:1024 nt
    s_waitcnt vmcnt(15)
    buffer_load_dwordx4 a[104:107], v0, s[48:51], s8 offen offset:2048 nt
    s_waitcnt vmcnt(15)
    buffer_load_dwordx4 a[108:111], v0, s[48:51], s8 offen offset:3072 nt
    s_waitcnt vmcnt(8)
    v_xor_b32 v36, v41, v3
    v_xor_b32 v37, v43, v3
    v_xor_b32 v38, v45, v3
    v_or3_b32 v36, v36, v37, v38
    v_xor_b32 v37, v47, v3
    v_or_b32 v36, v36, v37
    v_cmp_ne_u32 vcc, 0, v36
    s_cbranch_vccnz L_pf_4
    v_mov_b32 v4, v40
    v_mov_b32 v5, v42
    v_mov_b32 v6, v44
    v_mov_b32 v7, v46
    s_branch L_fast_7
L_pf_4:
    s_waitcnt vmcnt(15)
    buffer_load_dwordx4 v[40:43], v1, s[52:55], s9 offen sc1
    s_waitcnt vmcnt(15)
    buffer_load_dwordx4 v[44:47], v1, s[52:55], s9 offen offset:16 sc1
    s_add_u32 s8, s7, 802816
    s_waitcnt vmcnt(15)
    buffer_load_dwordx4 v[176:179], v0, s[44:47], s8 offen offset:0 nt
    s_waitcnt vmcnt(15)
    buffer_load_dwordx4 v[180:183], v0, s[44:47], s8 offen offset:1024 nt
    s_waitcnt vmcnt(15)
    buffer_load_dwordx4 v[184:187], v0, s[44:47], s8 offen offset:2048 nt
    s_waitcnt vmcnt(15)
    buffer_load_dwordx4 v[188:191], v0, s[44:47], s8 offen offset:3072 nt
    s_waitcnt vmcnt(15)
    buffer_load_dwordx4 a[112:115], v0, s[48:51], s8 offen offset:0 nt
    s_waitcnt vmcnt(15)
    buffer_load_dwordx4 a[116:119], v0, s[48:51], s8 offen offset:1024 nt
    s_waitcnt vmcnt(15)
    buffer_load_dwordx4 a[120:123], v0, s[48:51], s8 offen offset:2048 nt
    s_waitcnt vmcnt(15)
    buffer_load_dwordx4 a[124:127], v0, s[48:51], s8 offen offset:3072 nt
    s_waitcnt vmcnt(8)
    v_xor_b32 v36, v41, v3
    v_xor_b32 v37, v43, v3
    v_xor_b32 v38, v45, v3
    v_or3_b32 v36, v36, v37, v38
    v_xor_b32 v37, v47, v3
    v_or_b32 v36, v36, v37
    v_cmp_ne_u32 vcc, 0, v36
    s_cbranch_vccnz L_pf_5
    v_mov_b32 v4, v40
    v_mov_b32 v5, v42
    v_mov_b32 v6, v44
    v_mov_b32 v7, v46
    s_branch L_fast_8
L_pf_5:
    s_waitcnt vmcnt(15)
    buffer_load_dwordx4 v[40:43], v1, s[52:55], s9 offen sc1
    s_waitcnt vmcnt(15)
    buffer_load_dwordx4 v[44:47], v1, s[52:55], s9 offen offset:16 sc1
    s_add_u32 s8, s7, 917504
    s_waitcnt vmcnt(15)
    buffer_load_dwordx4 v[192:195], v0, s[44:47], s8 offen offset:0 nt
    s_waitcnt vmcnt(15)
    buffer_load_dwordx4 v[196:199], v0, s[44:47], s8 offen offset:1024 nt
    s_waitcnt vmcnt(15)
    buffer_load_dwordx4 v[200:203], v0, s[44:47], s8 offen offset:2048 nt
    s_waitcnt vmcnt(15)
    buffer_load_dwordx4 v[204:207], v0, s[44:47], s8 offen offset:3072 nt
    s_waitcnt vmcnt(15)
    buffer_load_dwordx4 a[128:131], v0, s[48:51], s8 offen offset:0 nt
    s_waitcnt vmcnt(15)
    buffer_load_dwordx4 a[132:135], v0, s[48:51], s8 offen offset:1024 nt
    s_waitcnt vmcnt(15)
    buffer_load_dwordx4 a[136:139], v0, s[48:51], s8 offen offset:2048 nt
    s_waitcnt vmcnt(15)
    buffer_load_dwordx4 a[140:143], v0, s[48:51], s8 offen offset:3072 nt
    s_waitcnt vmcnt(8)
    v_xor_b32 v36, v41, v3
    v_xor_b32 v37, v43, v3
    v_xor_b32 v38, v45, v3
    v_or3_b32 v36, v36, v37, v38
    v_xor_b32 v37, v47, v3
    v_or_b32 v36, v36, v37
    v_cmp_ne_u32 vcc, 0, v36
    s_cbranch_vccnz L_pf_6
    v_mov_b32 v4, v40
    v_mov_b32 v5, v42
    v_mov_b32 v6, v44
    v_mov_b32 v7, v46
    s_branch L_fast_9
L_pf_6:
    s_waitcnt vmcnt(15)
    buffer_load_dwordx4 v[40:43], v1, s[52:55], s9 offen sc1
    s_waitcnt vmcnt(15)
    buffer_load_dwordx4 v[44:47], v1, s[52:55], s9 offen offset:16 sc1
    s_add_u32 s8, s7, 1032192
    s_waitcnt vmcnt(15)
    buffer_load_dwordx4 v[208:211], v0, s[44:47], s8 offen offset:0 nt
    s_waitcnt vmcnt(15)
    buffer_load_dwordx4 v[212:215], v0, s[44:47], s8 offen offset:1024 nt
    s_waitcnt vmcnt(15)
    buffer_load_dwordx4 v[216:219], v0, s[44:47], s8 offen offset:2048 nt
    s_waitcnt vmcnt(15)
    buffer_load_dwordx4 v[220:223], v0, s[44:47], s8 offen offset:3072 nt
    s_waitcnt vmcnt(15)
    buffer_load_dwordx4 a[144:147], v0, s[48:51], s8 offen offset:0 nt
    s_waitcnt vmcnt(15)
    buffer_load_dwordx4 a[148:151], v0, s[48:51], s8 offen offset:1024 nt
    s_waitcnt vmcnt(15)
    buffer_load_dwordx4 a[152:155], v0, s[48:51], s8 offen offset:2048 nt
    s_waitcnt vmcnt(15)
    buffer_load_dwordx4 a[156:159], v0, s[48:51], s8 offen offset:3072 nt
    s_waitcnt vmcnt(8)
    v_xor_b32 v36, v41, v3
    v_xor_b32 v37, v43, v3
    v_xor_b32 v38, v45, v3
    v_or3_b32 v36, v36, v37, v38
    v_xor_b32 v37, v47, v3
    v_or_b32 v36, v36, v37
    v_cmp_ne_u32 vcc, 0, v36
    s_cbranch_vccnz L_pf_7
    v_mov_b32 v4, v40
    v_mov_b32 v5, v42
    v_mov_b32 v6, v44
    v_mov_b32 v7, v46
    s_branch L_fast_10
L_pf_7:
    s_waitcnt vmcnt(15)
    buffer_load_dwordx4 v[40:43], v1, s[52:55], s9 offen sc1
    s_waitcnt vmcnt(15)
    buffer_load_dwordx4 v[44:47], v1, s[52:55], s9 offen offset:16 sc1
    s_add_u32 s8, s7, 1146880
    s_waitcnt vmcnt(15)
    buffer_load_dwordx4 v[224:227], v0, s[44:47], s8 offen offset:0 nt
    s_waitcnt vmcnt(15)
    buffer_load_dwordx4 v[228:231], v0, s[44:47], s8 offen offset:1024 nt
    s_waitcnt vmcnt(15)
    buffer_load_dwordx4 v[232:235], v0, s[44:47], s8 offen offset:2048 nt
    s_waitcnt vmcnt(15)
    buffer_load_dwordx4 v[236:239], v0, s[44:47], s8 offen offset:3072 nt
    s_waitcnt vmcnt(15)
    buffer_load_dwordx4 a[160:163], v0, s[48:51], s8 offen offset:0 nt
    s_waitcnt vmcnt(15)
    buffer_load_dwordx4 a[164:167], v0, s[48:51], s8 offen offset:1024 nt
    s_waitcnt vmcnt(15)
    buffer_load_dwordx4 a[168:171], v0, s[48:51], s8 offen offset:2048 nt
    s_waitcnt vmcnt(15)
    buffer_load_dwordx4 a[172:175], v0, s[48:51], s8 offen offset:3072 nt
    s_waitcnt vmcnt(8)
    v_xor_b32 v36, v41, v3
    v_xor_b32 v37, v43, v3
    v_xor_b32 v38, v45, v3
    v_or3_b32 v36, v36, v37, v38
    v_xor_b32 v37, v47, v3
    v_or_b32 v36, v36, v37
    v_cmp_ne_u32 vcc, 0, v36
    s_cbranch_vccnz L_pf_8
    v_mov_b32 v4, v40
    v_mov_b32 v5, v42
    v_mov_b32 v6, v44
    v_mov_b32 v7, v46
    s_branch L_fast_11
L_pf_8:
    s_branch L_wq_pre
L_fast_5:
    s_add_u32 s8, s7, 573440
    s_waitcnt vmcnt(15)
    buffer_load_dwordx4 v[144:147], v0, s[44:47], s8 offen offset:0 nt
    s_waitcnt vmcnt(15)
    buffer_load_dwordx4 v[148:151], v0, s[44:47], s8 offen offset:1024 nt
    s_waitcnt vmcnt(15)
    buffer_load_dwordx4 v[152:155], v0, s[44:47], s8 offen offset:2048 nt
    s_waitcnt vmcnt(15)
    buffer_load_dwordx4 v[156:159], v0, s[44:47], s8 offen offset:3072 nt
    s_waitcnt vmcnt(15)
    buffer_load_dwordx4 a[80:83], v0, s[48:51], s8 offen offset:0 nt
    s_waitcnt vmcnt(15)
    buffer_load_dwordx4 a[84:87], v0, s[48:51], s8 offen offset:1024 nt
    s_waitcnt vmcnt(15)
    buffer_load_dwordx4 a[88:91], v0, s[48:51], s8 offen offset:2048 nt
    s_waitcnt vmcnt(15)
    buffer_load_dwordx4 a[92:95], v0, s[48:51], s8 offen offset:3072 nt
L_fast_6:
    s_add_u32 s8, s7, 688128
    s_waitcnt vmcnt(15)
    buffer_load_dwordx4 v[160:163], v0, s[44:47], s8 offen offset:0 nt
    s_waitcnt vmcnt(15)
    buffer_load_dwordx4 v[164:167], v0, s[44:47], s8 offen offset:1024 nt
    s_waitcnt vmcnt(15)
    buffer_load_dwordx4 v[168:171], v0, s[44:47], s8 offen offset:2048 nt
    s_waitcnt vmcnt(15)
    buffer_load_dwordx4 v[172:175], v0, s[44:47], s8 offen offset:3072 nt
    s_waitcnt vmcnt(15)
    buffer_load_dwordx4 a[96:99], v0, s[48:51], s8 offen offset:0 nt
    s_waitcnt vmcnt(15)
    buffer_load_dwordx4 a[100:103], v0, s[48:51], s8 offen offset:1024 nt
    s_waitcnt vmcnt(15)
    buffer_load_dwordx4 a[104:107], v0, s[48:51], s8 offen offset:2048 nt
    s_waitcnt vmcnt(15)
    buffer_load_dwordx4 a[108:111], v0, s[48:51], s8 offen offset:3072 nt
L_fast_7:
    s_add_u32 s8, s7, 802816
    s_waitcnt vmcnt(15)
    buffer_load_dwordx4 v[176:179], v0, s[44:47], s8 offen offset:0 nt
    s_waitcnt vmcnt(15)
    buffer_load_dwordx4 v[180:183], v0, s[44:47], s8 offen offset:1024 nt
    s_waitcnt vmcnt(15)
    buffer_load_dwordx4 v[184:187], v0, s[44:47], s8 offen offset:2048 nt
    s_waitcnt vmcnt(15)
    buffer_load_dwordx4 v[188:191], v0, s[44:47], s8 offen offset:3072 nt
    s_waitcnt vmcnt(15)
    buffer_load_dwordx4 a[112:115], v0, s[48:51], s8 offen offset:0 nt
    s_waitcnt vmcnt(15)
    buffer_load_dwordx4 a[116:119], v0, s[48:51], s8 offen offset:1024 nt
    s_waitcnt vmcnt(15)
    buffer_load_dwordx4 a[120:123], v0, s[48:51], s8 offen offset:2048 nt
    s_waitcnt vmcnt(15)
    buffer_load_dwordx4 a[124:127], v0, s[48:51], s8 offen offset:3072 nt
L_fast_8:
    s_add_u32 s8, s7, 917504
    s_waitcnt vmcnt(15)
    buffer_load_dwordx4 v[192:195], v0, s[44:47], s8 offen offset:0 nt
    s_waitcnt vmcnt(15)
    buffer_load_dwordx4 v[196:199], v0, s[44:47], s8 offen offset:1024 nt
    s_waitcnt vmcnt(15)
    buffer_load_dwordx4 v[200:203], v0, s[44:47], s8 offen offset:2048 nt
    s_waitcnt vmcnt(15)
    buffer_load_dwordx4 v[204:207], v0, s[44:47], s8 offen offset:3072 nt
    s_waitcnt vmcnt(15)
    buffer_load_dwordx4 a[128:131], v0, s[48:51], s8 offen offset:0 nt
    s_waitcnt vmcnt(15)
    buffer_load_dwordx4 a[132:135], v0, s[48:51], s8 offen offset:1024 nt
    s_waitcnt vmcnt(15)
    buffer_load_dwordx4 a[136:139], v0, s[48:51], s8 offen offset:2048 nt
    s_waitcnt vmcnt(15)
    buffer_load_dwordx4 a[140:143], v0, s[48:51], s8 offen offset:3072 nt
L_fast_9:
    s_add_u32 s8, s7, 1032192
    s_waitcnt vmcnt(15)
    buffer_load_dwordx4 v[208:211], v0, s[44:47], s8 offen offset:0 nt
    s_waitcnt vmcnt(15)
    buffer_load_dwordx4 v[212:215], v0, s[44:47], s8 offen offset:1024 nt
    s_waitcnt vmcnt(15)
    buffer_load_dwordx4 v[216:219], v0, s[44:47], s8 offen offset:2048 nt
    s_waitcnt vmcnt(15)
    buffer_load_dwordx4 v[220:223], v0, s[44:47], s8 offen offset:3072 nt
    s_waitcnt vmcnt(15)
    buffer_load_dwordx4 a[144:147], v0, s[48:51], s8 offen offset:0 nt
    s_waitcnt vmcnt(15)
    buffer_load_dwordx4 a[148:151], v0, s[48:51], s8 offen offset:1024 nt
    s_waitcnt vmcnt(15)
    buffer_load_dwordx4 a[152:155], v0, s[48:51], s8 offen offset:2048 nt
    s_waitcnt vmcnt(15)
    buffer_load_dwordx4 a[156:159], v0, s[48:51], s8 offen offset:3072 nt
L_fast_10:
    s_add_u32 s8, s7, 1146880
    s_waitcnt vmcnt(15)
    buffer_load_dwordx4 v[224:227], v0, s[44:47], s8 offen offset:0 nt
    s_waitcnt vmcnt(15)
    buffer_load_dwordx4 v[228:231], v0, s[44:47], s8 offen offset:1024 nt
    s_waitcnt vmcnt(15)
    buffer_load_dwordx4 v[232:235], v0, s[44:47], s8 offen offset:2048 nt
    s_waitcnt vmcnt(15)
    buffer_load_dwordx4 v[236:239], v0, s[44:47], s8 offen offset:3072 nt
    s_waitcnt vmcnt(15)
    buffer_load_dwordx4 a[160:163], v0, s[48:51], s8 offen offset:0 nt
    s_waitcnt vmcnt(15)
    buffer_load_dwordx4 a[164:167], v0, s[48:51], s8 offen offset:1024 nt
    s_waitcnt vmcnt(15)
    buffer_load_dwordx4 a[168:171], v0, s[48:51], s8 offen offset:2048 nt
    s_waitcnt vmcnt(15)
    buffer_load_dwordx4 a[172:175], v0, s[48:51], s8 offen offset:3072 nt
L_fast_11:
    s_branch L_wq_ok
L_wq_pre:
    s_mov_b32 s43, 0
    s_waitcnt vmcnt(0)
L_wq_spin:
    buffer_load_dwordx4 v[40:43], v1, s[52:55], s9 offen sc1
    buffer_load_dwordx4 v[44:47], v1, s[52:55], s9 offen offset:16 sc1
    s_waitcnt vmcnt(0)
    s_add_u32 s43, s43, 1
    s_cmp_gt_u32 s43, s42
    s_cbranch_scc1 L_wq_ok
    v_xor_b32 v36, v41, v3
    v_xor_b32 v37, v43, v3
    v_xor_b32 v38, v45, v3
    v_or3_b32 v36, v36, v37, v38
    v_xor_b32 v37, v47, v3
    v_or_b32 v36, v36, v37
    v_cmp_ne_u32 vcc, 0, v36
    s_nop 4
    s_cbranch_vccnz L_wq_spin
    v_mov_b32 v4, v40
    v_mov_b32 v5, v42
    v_mov_b32 v6, v44
    v_mov_b32 v7, v46
L_wq_ok:
    s_lshl_b32 s16, s4, 15
    s_lshl_b32 s11, s5, 3
    s_add_u32 s15, s16, s11
    s_add_u32 s15, s15, 81920
    s_lshl_b32 s11, s5, 9
    s_add_u32 s16, s16, s11
    s_add_u32 s16, s16, 65536
    v_lshrrev_b32 v52, 4, v0
    v_and_b32 v51, 15, v52
    v_lshlrev_b32 v51, 5, v51
    v_lshrrev_b32 v52, 4, v52
    v_lshl_add_u32 v51, v52, 4, v51
    v_mov_b32 v52, 0
    v_lshrrev_b32 v2, 4, v0
    s_add_u32 s8, s7, 1261568
    s_waitcnt vmcnt(15)
    buffer_load_dwordx4 v[240:243], v0, s[44:47], s8 offen offset:0 nt
    s_waitcnt vmcnt(15)
    buffer_load_dwordx4 v[244:247], v0, s[44:47], s8 offen offset:1024 nt
    s_waitcnt vmcnt(15)
    buffer_load_dwordx4 v[248:251], v0, s[44:47], s8 offen offset:2048 nt
    s_waitcnt vmcnt(15)
    buffer_load_dwordx4 v[252:255], v0, s[44:47], s8 offen offset:3072 nt
    s_waitcnt vmcnt(15)
    buffer_load_dwordx4 a[176:179], v0, s[48:51], s8 offen offset:0 nt
    s_waitcnt vmcnt(15)
    buffer_load_dwordx4 a[180:183], v0, s[48:51], s8 offen offset:1024 nt
    s_waitcnt vmcnt(15)
    buffer_load_dwordx4 a[184:187], v0, s[48:51], s8 offen offset:2048 nt
    s_waitcnt vmcnt(15)
    buffer_load_dwordx4 a[188:191], v0, s[48:51], s8 offen offset:3072 nt
    s_waitcnt vmcnt(63)
    v_dot2_f32_bf16 v28, v64, v4, 0
    v_dot2_f32_bf16 v29, v68, v4, 0
    v_dot2_f32_bf16 v30, v72, v4, 0
    v_dot2_f32_bf16 v31, v76, v4, 0
    v_dot2c_f32_bf16 v28, v65, v5
    v_dot2c_f32_bf16 v29, v69, v5
    v_dot2c_f32_bf16 v30, v73, v5
    v_dot2c_f32_bf16 v31, v77, v5
    v_dot2c_f32_bf16 v28, v66, v6
    v_dot2c_f32_bf16 v29, v70, v6
    v_dot2c_f32_bf16 v30, v74, v6
    v_dot2c_f32_bf16 v31, v78, v6
    v_dot2c_f32_bf16 v28, v67, v7
    v_dot2c_f32_bf16 v29, v71, v7
    v_dot2c_f32_bf16 v30, v75, v7
    v_dot2c_f32_bf16 v31, v79, v7
    v_add_f32_dpp v32, v28, v28 row_ror:8 row_mask:0xf bank_mask:0x3
    s_nop 0
    v_add_f32_dpp v33, v30, v30 row_ror:8 row_mask:0xf bank_mask:0x3
    v_add_f32_dpp v32, v29, v29 row_ror:8 row_mask:0xf bank_mask:0xc
    v_add_f32_dpp v33, v31, v31 row_ror:8 row_mask:0xf bank_mask:0xc
    s_nop 0
    v_add_f32_dpp v34, v32, v32 row_shl:4 row_mask:0xf bank_mask:0x5
    v_add_f32_dpp v34, v33, v33 row_shr:4 row_mask:0xf bank_mask:0xa
    s_nop 1
    v_add_f32_dpp v34, v34, v34 quad_perm:[2,3,0,1] row_mask:0xf bank_mask:0xf
    s_nop 1
    v_add_f32_dpp v34, v34, v34 quad_perm:[1,0,3,2] row_mask:0xf bank_mask:0xf
    v_cvt_pk_bf16_f32 v36, v34, v34
    v_and_b32 v34, 0xffff0000, v36
    v_mul_f32 v34, 0x3db504f3, v34
    v_cvt_pk_bf16_f32 v36, v34, v34
    v_and_b32 v34, 0xffff0000, v36
    s_nop 1
    v_max_f32_dpp v36, v34, v34 row_ror:4 row_mask:0xf bank_mask:0xf
    s_nop 1
    v_max_f32_dpp v36, v36, v36 row_ror:8 row_mask:0xf bank_mask:0xf
    v_mov_b32 v37, v36
    s_nop 1
    v_permlane16_swap_b32 v36, v37
    v_max_f32 v36, v36, v37
    v_mov_b32 v37, v36
    s_nop 1
    v_permlane32_swap_b32 v36, v37
    v_max_f32 v36, v36, v37
    v_mov_b32 v24, v36
    v_sub_f32 v37, v34, v24
    v_mul_f32 v37, 0x3fb8aa3b, v37
    v_exp_f32 v25, v37
    s_nop 0
    v_cvt_pk_bf16_f32 v35, v25, v25
    s_waitcnt vmcnt(63)
    s_nop 0
    v_and_b32_dpp v16, v35, v8 row_newbcast:0 row_mask:0xf bank_mask:0xf
    v_and_b32_dpp v17, v35, v9 row_newbcast:0 row_mask:0xf bank_mask:0xf
    v_and_b32_dpp v18, v35, v10 row_newbcast:0 row_mask:0xf bank_mask:0xf
    v_and_b32_dpp v19, v35, v11 row_newbcast:0 row_mask:0xf bank_mask:0xf
    v_and_b32_dpp v20, v35, v8 row_newbcast:8 row_mask:0xf bank_mask:0xf
    v_and_b32_dpp v21, v35, v9 row_newbcast:8 row_mask:0xf bank_mask:0xf
    v_and_b32_dpp v22, v35, v10 row_newbcast:8 row_mask:0xf bank_mask:0xf
    v_and_b32_dpp v23, v35, v11 row_newbcast:8 row_mask:0xf bank_mask:0xf
    v_mfma_f32_16x16x32_bf16 v[12:15], v[16:19], a[0:3], 0
    v_and_b32_dpp v16, v35, v8 row_newbcast:4 row_mask:0xf bank_mask:0xf
    v_and_b32_dpp v17, v35, v9 row_newbcast:4 row_mask:0xf bank_mask:0xf
    v_and_b32_dpp v18, v35, v10 row_newbcast:4 row_mask:0xf bank_mask:0xf
    v_and_b32_dpp v19, v35, v11 row_newbcast:4 row_mask:0xf bank_mask:0xf
    v_mfma_f32_16x16x32_bf16 v[12:15], v[20:23], a[4:7], v[12:15]
    v_and_b32_dpp v20, v35, v8 row_newbcast:12 row_mask:0xf bank_mask:0xf
    v_and_b32_dpp v21, v35, v9 row_newbcast:12 row_mask:0xf bank_mask:0xf
    v_and_b32_dpp v22, v35, v10 row_newbcast:12 row_mask:0xf bank_mask:0xf
    v_and_b32_dpp v23, v35, v11 row_newbcast:12 row_mask:0xf bank_mask:0xf
    v_mfma_f32_16x16x32_bf16 v[12:15], v[16:19], a[8:11], v[12:15]
    s_nop 0
    v_mfma_f32_16x16x32_bf16 v[12:15], v[20:23], a[12:15], v[12:15]
    s_waitcnt vmcnt(63)
    v_dot2_f32_bf16 v28, v80, v4, 0
    v_dot2_f32_bf16 v29, v84, v4, 0
    v_dot2_f32_bf16 v30, v88, v4, 0
    v_dot2_f32_bf16 v31, v92, v4, 0
    v_dot2c_f32_bf16 v28, v81, v5
    v_dot2c_f32_bf16 v29, v85, v5
    v_dot2c_f32_bf16 v30, v89, v5
    v_dot2c_f32_bf16 v31, v93, v5
    v_dot2c_f32_bf16 v28, v82, v6
    v_dot2c_f32_bf16 v29, v86, v6
    v_dot2c_f32_bf16 v30, v90, v6
    v_dot2c_f32_bf16 v31, v94, v6
    v_dot2c_f32_bf16 v28, v83, v7
    v_dot2c_f32_bf16 v29, v87, v7
    v_dot2c_f32_bf16 v30, v91, v7
    v_dot2c_f32_bf16 v31, v95, v7
    v_add_f32_dpp v32, v28, v28 row_ror:8 row_mask:0xf bank_mask:0x3
    s_nop 0
    v_add_f32_dpp v33, v30, v30 row_ror:8 row_mask:0xf bank_mask:0x3
    v_add_f32_dpp v32, v29, v29 row_ror:8 row_mask:0xf bank_mask:0xc
    v_add_f32_dpp v33, v31, v31 row_ror:8 row_mask:0xf bank_mask:0xc
    s_nop 0
    v_add_f32_dpp v34, v32, v32 row_shl:4 row_mask:0xf bank_mask:0x5
    v_add_f32_dpp v34, v33, v33 row_shr:4 row_mask:0xf bank_mask:0xa
    s_nop 1
    v_add_f32_dpp v34, v34, v34 quad_perm:[2,3,0,1] row_mask:0xf bank_mask:0xf
    s_nop 1
    v_add_f32_dpp v34, v34, v34 quad_perm:[1,0,3,2] row_mask:0xf bank_mask:0xf
    v_cvt_pk_bf16_f32 v36, v34, v34
    v_and_b32 v34, 0xffff0000, v36
    v_mul_f32 v34, 0x3db504f3, v34
    v_cvt_pk_bf16_f32 v36, v34, v34
    v_and_b32 v34, 0xffff0000, v36
    s_nop 1
    v_max_f32_dpp v36, v34, v34 row_ror:4 row_mask:0xf bank_mask:0xf
    s_nop 1
    v_max_f32_dpp v36, v36, v36 row_ror:8 row_mask:0xf bank_mask:0xf
    v_mov_b32 v37, v36
    s_nop 1
    v_permlane16_swap_b32 v36, v37
    v_max_f32 v36, v36, v37
    v_mov_b32 v37, v36
    s_nop 1
    v_permlane32_swap_b32 v36, v37
    v_max_f32 v36, v36, v37
    v_max_f32 v36, v36, v24
    v_sub_f32 v37, v34, v36
    v_sub_f32 v38, v24, v36
    v_mul_f32 v37, 0x3fb8aa3b, v37
    v_mul_f32 v38, 0x3fb8aa3b, v38
    v_exp_f32 v37, v37
    v_exp_f32 v26, v38
    v_mov_b32 v24, v36
    v_cvt_pk_bf16_f32 v35, v37, v37
    v_fma_f32 v25, v25, v26, v37
    v_mul_f32 v12, v12, v26
    v_mul_f32 v13, v13, v26
    v_mul_f32 v14, v14, v26
    v_mul_f32 v15, v15, v26
    s_waitcnt vmcnt(63)
    v_and_b32_dpp v16, v35, v8 row_newbcast:0 row_mask:0xf bank_mask:0xf
    v_and_b32_dpp v17, v35, v9 row_newbcast:0 row_mask:0xf bank_mask:0xf
    v_and_b32_dpp v18, v35, v10 row_newbcast:0 row_mask:0xf bank_mask:0xf
    v_and_b32_dpp v19, v35, v11 row_newbcast:0 row_mask:0xf bank_mask:0xf
    v_and_b32_dpp v20, v35, v8 row_newbcast:8 row_mask:0xf bank_mask:0xf
    v_and_b32_dpp v21, v35, v9 row_newbcast:8 row_mask:0xf bank_mask:0xf
    v_and_b32_dpp v22, v35, v10 row_newbcast:8 row_mask:0xf bank_mask:0xf
    v_and_b32_dpp v23, v35, v11 row_newbcast:8 row_mask:0xf bank_mask:0xf
    v_mfma_f32_16x16x32_bf16 v[12:15], v[16:19], a[16:19], v[12:15]
    v_and_b32_dpp v16, v35, v8 row_newbcast:4 row_mask:0xf bank_mask:0xf
    v_and_b32_dpp v17, v35, v9 row_newbcast:4 row_mask:0xf bank_mask:0xf
    v_and_b32_dpp v18, v35, v10 row_newbcast:4 row_mask:0xf bank_mask:0xf
    v_and_b32_dpp v19, v35, v11 row_newbcast:4 row_mask:0xf bank_mask:0xf
    v_mfma_f32_16x16x32_bf16 v[12:15], v[20:23], a[20:23], v[12:15]
    v_and_b32_dpp v20, v35, v8 row_newbcast:12 row_mask:0xf bank_mask:0xf
    v_and_b32_dpp v21, v35, v9 row_newbcast:12 row_mask:0xf bank_mask:0xf
    v_and_b32_dpp v22, v35, v10 row_newbcast:12 row_mask:0xf bank_mask:0xf
    v_and_b32_dpp v23, v35, v11 row_newbcast:12 row_mask:0xf bank_mask:0xf
    v_mfma_f32_16x16x32_bf16 v[12:15], v[16:19], a[24:27], v[12:15]
    s_nop 0
    v_mfma_f32_16x16x32_bf16 v[12:15], v[20:23], a[28:31], v[12:15]
    s_waitcnt vmcnt(63)
    v_dot2_f32_bf16 v28, v96, v4, 0
    v_dot2_f32_bf16 v29, v100, v4, 0
    v_dot2_f32_bf16 v30, v104, v4, 0
    v_dot2_f32_bf16 v31, v108, v4, 0
    v_dot2c_f32_bf16 v28, v97, v5
    v_dot2c_f32_bf16 v29, v101, v5
    v_dot2c_f32_bf16 v30, v105, v5
    v_dot2c_f32_bf16 v31, v109, v5
    v_dot2c_f32_bf16 v28, v98, v6
    v_dot2c_f32_bf16 v29, v102, v6
    v_dot2c_f32_bf16 v30, v106, v6
    v_dot2c_f32_bf16 v31, v110, v6
    v_dot2c_f32_bf16 v28, v99, v7
    v_dot2c_f32_bf16 v29, v103, v7
    v_dot2c_f32_bf16 v30, v107, v7
    v_dot2c_f32_bf16 v31, v111, v7
    v_add_f32_dpp v32, v28, v28 row_ror:8 row_mask:0xf bank_mask:0x3
    s_nop 0
    v_add_f32_dpp v33, v30, v30 row_ror:8 row_mask:0xf bank_mask:0x3
    v_add_f32_dpp v32, v29, v29 row_ror:8 row_mask:0xf bank_mask:0xc
    v_add_f32_dpp v33, v31, v31 row_ror:8 row_mask:0xf bank_mask:0xc
    s_nop 0
    v_add_f32_dpp v34, v32, v32 row_shl:4 row_mask:0xf bank_mask:0x5
    v_add_f32_dpp v34, v33, v33 row_shr:4 row_mask:0xf bank_mask:0xa
    s_nop 1
    v_add_f32_dpp v34, v34, v34 quad_perm:[2,3,0,1] row_mask:0xf bank_mask:0xf
    s_nop 1
    v_add_f32_dpp v34, v34, v34 quad_perm:[1,0,3,2] row_mask:0xf bank_mask:0xf
    v_cvt_pk_bf16_f32 v36, v34, v34
    v_and_b32 v34, 0xffff0000, v36
    v_mul_f32 v34, 0x3db504f3, v34
    v_cvt_pk_bf16_f32 v36, v34, v34
    v_and_b32 v34, 0xffff0000, v36
    s_nop 1
    v_max_f32_dpp v36, v34, v34 row_ror:4 row_mask:0xf bank_mask:0xf
    s_nop 1
    v_max_f32_dpp v36, v36, v36 row_ror:8 row_mask:0xf bank_mask:0xf
    v_mov_b32 v37, v36
    s_nop 1
    v_permlane16_swap_b32 v36, v37
    v_max_f32 v36, v36, v37
    v_mov_b32 v37, v36
    s_nop 1
    v_permlane32_swap_b32 v36, v37
    v_max_f32 v36, v36, v37
    v_max_f32 v36, v36, v24
    v_sub_f32 v37, v34, v36
    v_sub_f32 v38, v24, v36
    v_mul_f32 v37, 0x3fb8aa3b, v37
    v_mul_f32 v38, 0x3fb8aa3b, v38
    v_exp_f32 v37, v37
    v_exp_f32 v26, v38
    v_mov_b32 v24, v36
    v_cvt_pk_bf16_f32 v35, v37, v37
    v_fma_f32 v25, v25, v26, v37
    v_mul_f32 v12, v12, v26
    v_mul_f32 v13, v13, v26
    v_mul_f32 v14, v14, v26
    v_mul_f32 v15, v15, v26
    s_waitcnt vmcnt(63)
    v_and_b32_dpp v16, v35, v8 row_newbcast:0 row_mask:0xf bank_mask:0xf
    v_and_b32_dpp v17, v35, v9 row_newbcast:0 row_mask:0xf bank_mask:0xf
    v_and_b32_dpp v18, v35, v10 row_newbcast:0 row_mask:0xf bank_mask:0xf
    v_and_b32_dpp v19, v35, v11 row_newbcast:0 row_mask:0xf bank_mask:0xf
    v_and_b32_dpp v20, v35, v8 row_newbcast:8 row_mask:0xf bank_mask:0xf
    v_and_b32_dpp v21, v35, v9 row_newbcast:8 row_mask:0xf bank_mask:0xf
    v_and_b32_dpp v22, v35, v10 row_newbcast:8 row_mask:0xf bank_mask:0xf
    v_and_b32_dpp v23, v35, v11 row_newbcast:8 row_mask:0xf bank_mask:0xf
    v_mfma_f32_16x16x32_bf16 v[12:15], v[16:19], a[32:35], v[12:15]
    v_and_b32_dpp v16, v35, v8 row_newbcast:4 row_mask:0xf bank_mask:0xf
    v_and_b32_dpp v17, v35, v9 row_newbcast:4 row_mask:0xf bank_mask:0xf
    v_and_b32_dpp v18, v35, v10 row_newbcast:4 row_mask:0xf bank_mask:0xf
    v_and_b32_dpp v19, v35, v11 row_newbcast:4 row_mask:0xf bank_mask:0xf
    v_mfma_f32_16x16x32_bf16 v[12:15], v[20:23], a[36:39], v[12:15]
    v_and_b32_dpp v20, v35, v8 row_newbcast:12 row_mask:0xf bank_mask:0xf
    v_and_b32_dpp v21, v35, v9 row_newbcast:12 row_mask:0xf bank_mask:0xf
    v_and_b32_dpp v22, v35, v10 row_newbcast:12 row_mask:0xf bank_mask:0xf
    v_and_b32_dpp v23, v35, v11 row_newbcast:12 row_mask:0xf bank_mask:0xf
    v_mfma_f32_16x16x32_bf16 v[12:15], v[16:19], a[40:43], v[12:15]
    s_nop 0
    v_mfma_f32_16x16x32_bf16 v[12:15], v[20:23], a[44:47], v[12:15]
    s_waitcnt vmcnt(63)
    v_dot2_f32_bf16 v28, v112, v4, 0
    v_dot2_f32_bf16 v29, v116, v4, 0
    v_dot2_f32_bf16 v30, v120, v4, 0
    v_dot2_f32_bf16 v31, v124, v4, 0
    v_dot2c_f32_bf16 v28, v113, v5
    v_dot2c_f32_bf16 v29, v117, v5
    v_dot2c_f32_bf16 v30, v121, v5
    v_dot2c_f32_bf16 v31, v125, v5
    v_dot2c_f32_bf16 v28, v114, v6
    v_dot2c_f32_bf16 v29, v118, v6
    v_dot2c_f32_bf16 v30, v122, v6
    v_dot2c_f32_bf16 v31, v126, v6
    v_dot2c_f32_bf16 v28, v115, v7
    v_dot2c_f32_bf16 v29, v119, v7
    v_dot2c_f32_bf16 v30, v123, v7
    v_dot2c_f32_bf16 v31, v127, v7
    v_add_f32_dpp v32, v28, v28 row_ror:8 row_mask:0xf bank_mask:0x3
    s_nop 0
    v_add_f32_dpp v33, v30, v30 row_ror:8 row_mask:0xf bank_mask:0x3
    v_add_f32_dpp v32, v29, v29 row_ror:8 row_mask:0xf bank_mask:0xc
    v_add_f32_dpp v33, v31, v31 row_ror:8 row_mask:0xf bank_mask:0xc
    s_nop 0
    v_add_f32_dpp v34, v32, v32 row_shl:4 row_mask:0xf bank_mask:0x5
    v_add_f32_dpp v34, v33, v33 row_shr:4 row_mask:0xf bank_mask:0xa
    s_nop 1
    v_add_f32_dpp v34, v34, v34 quad_perm:[2,3,0,1] row_mask:0xf bank_mask:0xf
    s_nop 1
    v_add_f32_dpp v34, v34, v34 quad_perm:[1,0,3,2] row_mask:0xf bank_mask:0xf
    v_cvt_pk_bf16_f32 v36, v34, v34
    v_and_b32 v34, 0xffff0000, v36
    v_mul_f32 v34, 0x3db504f3, v34
    v_cvt_pk_bf16_f32 v36, v34, v34
    v_and_b32 v34, 0xffff0000, v36
    s_nop 1
    v_max_f32_dpp v36, v34, v34 row_ror:4 row_mask:0xf bank_mask:0xf
    s_nop 1
    v_max_f32_dpp v36, v36, v36 row_ror:8 row_mask:0xf bank_mask:0xf
    v_mov_b32 v37, v36
    s_nop 1
    v_permlane16_swap_b32 v36, v37
    v_max_f32 v36, v36, v37
    v_mov_b32 v37, v36
    s_nop 1
    v_permlane32_swap_b32 v36, v37
    v_max_f32 v36, v36, v37
    v_max_f32 v36, v36, v24
    v_sub_f32 v37, v34, v36
    v_sub_f32 v38, v24, v36
    v_mul_f32 v37, 0x3fb8aa3b, v37
    v_mul_f32 v38, 0x3fb8aa3b, v38
    v_exp_f32 v37, v37
    v_exp_f32 v26, v38
    v_mov_b32 v24, v36
    v_cvt_pk_bf16_f32 v35, v37, v37
    v_fma_f32 v25, v25, v26, v37
    v_mul_f32 v12, v12, v26
    v_mul_f32 v13, v13, v26
    v_mul_f32 v14, v14, v26
    v_mul_f32 v15, v15, v26
    s_waitcnt vmcnt(63)
    v_and_b32_dpp v16, v35, v8 row_newbcast:0 row_mask:0xf bank_mask:0xf
    v_and_b32_dpp v17, v35, v9 row_newbcast:0 row_mask:0xf bank_mask:0xf
    v_and_b32_dpp v18, v35, v10 row_newbcast:0 row_mask:0xf bank_mask:0xf
    v_and_b32_dpp v19, v35, v11 row_newbcast:0 row_mask:0xf bank_mask:0xf
    v_and_b32_dpp v20, v35, v8 row_newbcast:8 row_mask:0xf bank_mask:0xf
    v_and_b32_dpp v21, v35, v9 row_newbcast:8 row_mask:0xf bank_mask:0xf
    v_and_b32_dpp v22, v35, v10 row_newbcast:8 row_mask:0xf bank_mask:0xf
    v_and_b32_dpp v23, v35, v11 row_newbcast:8 row_mask:0xf bank_mask:0xf
    v_mfma_f32_16x16x32_bf16 v[12:15], v[16:19], a[48:51], v[12:15]
    v_and_b32_dpp v16, v35, v8 row_newbcast:4 row_mask:0xf bank_mask:0xf
    v_and_b32_dpp v17, v35, v9 row_newbcast:4 row_mask:0xf bank_mask:0xf
    v_and_b32_dpp v18, v35, v10 row_newbcast:4 row_mask:0xf bank_mask:0xf
    v_and_b32_dpp v19, v35, v11 row_newbcast:4 row_mask:0xf bank_mask:0xf
    v_mfma_f32_16x16x32_bf16 v[12:15], v[20:23], a[52:55], v[12:15]
    v_and_b32_dpp v20, v35, v8 row_newbcast:12 row_mask:0xf bank_mask:0xf
    v_and_b32_dpp v21, v35, v9 row_newbcast:12 row_mask:0xf bank_mask:0xf
    v_and_b32_dpp v22, v35, v10 row_newbcast:12 row_mask:0xf bank_mask:0xf
    v_and_b32_dpp v23, v35, v11 row_newbcast:12 row_mask:0xf bank_mask:0xf
    v_mfma_f32_16x16x32_bf16 v[12:15], v[16:19], a[56:59], v[12:15]
    s_nop 0
    v_mfma_f32_16x16x32_bf16 v[12:15], v[20:23], a[60:63], v[12:15]
    s_add_u32 s8, s7, 1376256
    s_waitcnt vmcnt(15)
    buffer_load_dwordx4 v[64:67], v0, s[44:47], s8 offen offset:0 nt
    s_waitcnt vmcnt(15)
    buffer_load_dwordx4 v[68:71], v0, s[44:47], s8 offen offset:1024 nt
    s_waitcnt vmcnt(15)
    buffer_load_dwordx4 v[72:75], v0, s[44:47], s8 offen offset:2048 nt
    s_waitcnt vmcnt(15)
    buffer_load_dwordx4 v[76:79], v0, s[44:47], s8 offen offset:3072 nt
    s_waitcnt vmcnt(15)
    buffer_load_dwordx4 a[0:3], v0, s[48:51], s8 offen offset:0 nt
    s_waitcnt vmcnt(15)
    buffer_load_dwordx4 a[4:7], v0, s[48:51], s8 offen offset:1024 nt
    s_waitcnt vmcnt(15)
    buffer_load_dwordx4 a[8:11], v0, s[48:51], s8 offen offset:2048 nt
    s_waitcnt vmcnt(15)
    buffer_load_dwordx4 a[12:15], v0, s[48:51], s8 offen offset:3072 nt
    s_waitcnt vmcnt(63)
    v_dot2_f32_bf16 v28, v128, v4, 0
    v_dot2_f32_bf16 v29, v132, v4, 0
    v_dot2_f32_bf16 v30, v136, v4, 0
    v_dot2_f32_bf16 v31, v140, v4, 0
    v_dot2c_f32_bf16 v28, v129, v5
    v_dot2c_f32_bf16 v29, v133, v5
    v_dot2c_f32_bf16 v30, v137, v5
    v_dot2c_f32_bf16 v31, v141, v5
    v_dot2c_f32_bf16 v28, v130, v6
    v_dot2c_f32_bf16 v29, v134, v6
    v_dot2c_f32_bf16 v30, v138, v6
    v_dot2c_f32_bf16 v31, v142, v6
    v_dot2c_f32_bf16 v28, v131, v7
    v_dot2c_f32_bf16 v29, v135, v7
    v_dot2c_f32_bf16 v30, v139, v7
    v_dot2c_f32_bf16 v31, v143, v7
    v_add_f32_dpp v32, v28, v28 row_ror:8 row_mask:0xf bank_mask:0x3
    s_nop 0
    v_add_f32_dpp v33, v30, v30 row_ror:8 row_mask:0xf bank_mask:0x3
    v_add_f32_dpp v32, v29, v29 row_ror:8 row_mask:0xf bank_mask:0xc
    v_add_f32_dpp v33, v31, v31 row_ror:8 row_mask:0xf bank_mask:0xc
    s_nop 0
    v_add_f32_dpp v34, v32, v32 row_shl:4 row_mask:0xf bank_mask:0x5
    v_add_f32_dpp v34, v33, v33 row_shr:4 row_mask:0xf bank_mask:0xa
    s_nop 1
    v_add_f32_dpp v34, v34, v34 quad_perm:[2,3,0,1] row_mask:0xf bank_mask:0xf
    s_nop 1
    v_add_f32_dpp v34, v34, v34 quad_perm:[1,0,3,2] row_mask:0xf bank_mask:0xf
    v_cvt_pk_bf16_f32 v36, v34, v34
    v_and_b32 v34, 0xffff0000, v36
    v_mul_f32 v34, 0x3db504f3, v34
    v_cvt_pk_bf16_f32 v36, v34, v34
    v_and_b32 v34, 0xffff0000, v36
    s_nop 1
    v_max_f32_dpp v36, v34, v34 row_ror:4 row_mask:0xf bank_mask:0xf
    s_nop 1
    v_max_f32_dpp v36, v36, v36 row_ror:8 row_mask:0xf bank_mask:0xf
    v_mov_b32 v37, v36
    s_nop 1
    v_permlane16_swap_b32 v36, v37
    v_max_f32 v36, v36, v37
    v_mov_b32 v37, v36
    s_nop 1
    v_permlane32_swap_b32 v36, v37
    v_max_f32 v36, v36, v37
    v_max_f32 v36, v36, v24
    v_sub_f32 v37, v34, v36
    v_sub_f32 v38, v24, v36
    v_mul_f32 v37, 0x3fb8aa3b, v37
    v_mul_f32 v38, 0x3fb8aa3b, v38
    v_exp_f32 v37, v37
    v_exp_f32 v26, v38
    v_mov_b32 v24, v36
    v_cvt_pk_bf16_f32 v35, v37, v37
    v_fma_f32 v25, v25, v26, v37
    v_mul_f32 v12, v12, v26
    v_mul_f32 v13, v13, v26
    v_mul_f32 v14, v14, v26
    v_mul_f32 v15, v15, v26
    s_waitcnt vmcnt(63)
    v_and_b32_dpp v16, v35, v8 row_newbcast:0 row_mask:0xf bank_mask:0xf
    v_and_b32_dpp v17, v35, v9 row_newbcast:0 row_mask:0xf bank_mask:0xf
    v_and_b32_dpp v18, v35, v10 row_newbcast:0 row_mask:0xf bank_mask:0xf
    v_and_b32_dpp v19, v35, v11 row_newbcast:0 row_mask:0xf bank_mask:0xf
    v_and_b32_dpp v20, v35, v8 row_newbcast:8 row_mask:0xf bank_mask:0xf
    v_and_b32_dpp v21, v35, v9 row_newbcast:8 row_mask:0xf bank_mask:0xf
    v_and_b32_dpp v22, v35, v10 row_newbcast:8 row_mask:0xf bank_mask:0xf
    v_and_b32_dpp v23, v35, v11 row_newbcast:8 row_mask:0xf bank_mask:0xf
    v_mfma_f32_16x16x32_bf16 v[12:15], v[16:19], a[64:67], v[12:15]
    v_and_b32_dpp v16, v35, v8 row_newbcast:4 row_mask:0xf bank_mask:0xf
    v_and_b32_dpp v17, v35, v9 row_newbcast:4 row_mask:0xf bank_mask:0xf
    v_and_b32_dpp v18, v35, v10 row_newbcast:4 row_mask:0xf bank_mask:0xf
    v_and_b32_dpp v19, v35, v11 row_newbcast:4 row_mask:0xf bank_mask:0xf
    v_mfma_f32_16x16x32_bf16 v[12:15], v[20:23], a[68:71], v[12:15]
    v_and_b32_dpp v20, v35, v8 row_newbcast:12 row_mask:0xf bank_mask:0xf
    v_and_b32_dpp v21, v35, v9 row_newbcast:12 row_mask:0xf bank_mask:0xf
    v_and_b32_dpp v22, v35, v10 row_newbcast:12 row_mask:0xf bank_mask:0xf
    v_and_b32_dpp v23, v35, v11 row_newbcast:12 row_mask:0xf bank_mask:0xf
    v_mfma_f32_16x16x32_bf16 v[12:15], v[16:19], a[72:75], v[12:15]
    s_nop 0
    v_mfma_f32_16x16x32_bf16 v[12:15], v[20:23], a[76:79], v[12:15]
    s_waitcnt vmcnt(60)
    v_dot2_f32_bf16 v28, v144, v4, 0
    v_dot2_f32_bf16 v29, v148, v4, 0
    v_dot2_f32_bf16 v30, v152, v4, 0
    v_dot2_f32_bf16 v31, v156, v4, 0
    v_dot2c_f32_bf16 v28, v145, v5
    v_dot2c_f32_bf16 v29, v149, v5
    v_dot2c_f32_bf16 v30, v153, v5
    v_dot2c_f32_bf16 v31, v157, v5
    v_dot2c_f32_bf16 v28, v146, v6
    v_dot2c_f32_bf16 v29, v150, v6
    v_dot2c_f32_bf16 v30, v154, v6
    v_dot2c_f32_bf16 v31, v158, v6
    v_dot2c_f32_bf16 v28, v147, v7
    v_dot2c_f32_bf16 v29, v151, v7
    v_dot2c_f32_bf16 v30, v155, v7
    v_dot2c_f32_bf16 v31, v159, v7
    v_add_f32_dpp v32, v28, v28 row_ror:8 row_mask:0xf bank_mask:0x3
    s_nop 0
    v_add_f32_dpp v33, v30, v30 row_ror:8 row_mask:0xf bank_mask:0x3
    v_add_f32_dpp v32, v29, v29 row_ror:8 row_mask:0xf bank_mask:0xc
    v_add_f32_dpp v33, v31, v31 row_ror:8 row_mask:0xf bank_mask:0xc
    s_nop 0
    v_add_f32_dpp v34, v32, v32 row_shl:4 row_mask:0xf bank_mask:0x5
    v_add_f32_dpp v34, v33, v33 row_shr:4 row_mask:0xf bank_mask:0xa
    s_nop 1
    v_add_f32_dpp v34, v34, v34 quad_perm:[2,3,0,1] row_mask:0xf bank_mask:0xf
    s_nop 1
    v_add_f32_dpp v34, v34, v34 quad_perm:[1,0,3,2] row_mask:0xf bank_mask:0xf
    v_cvt_pk_bf16_f32 v36, v34, v34
    v_and_b32 v34, 0xffff0000, v36
    v_mul_f32 v34, 0x3db504f3, v34
    v_cvt_pk_bf16_f32 v36, v34, v34
    v_and_b32 v34, 0xffff0000, v36
    s_nop 1
    v_max_f32_dpp v36, v34, v34 row_ror:4 row_mask:0xf bank_mask:0xf
    s_nop 1
    v_max_f32_dpp v36, v36, v36 row_ror:8 row_mask:0xf bank_mask:0xf
    v_mov_b32 v37, v36
    s_nop 1
    v_permlane16_swap_b32 v36, v37
    v_max_f32 v36, v36, v37
    v_mov_b32 v37, v36
    s_nop 1
    v_permlane32_swap_b32 v36, v37
    v_max_f32 v36, v36, v37
    v_max_f32 v36, v36, v24
    v_sub_f32 v37, v34, v36
    v_sub_f32 v38, v24, v36
    v_mul_f32 v37, 0x3fb8aa3b, v37
    v_mul_f32 v38, 0x3fb8aa3b, v38
    v_exp_f32 v37, v37
    v_exp_f32 v26, v38
    v_mov_b32 v24, v36
    v_cvt_pk_bf16_f32 v35, v37, v37
    v_fma_f32 v25, v25, v26, v37
    v_mul_f32 v12, v12, v26
    v_mul_f32 v13, v13, v26
    v_mul_f32 v14, v14, v26
    v_mul_f32 v15, v15, v26
    s_waitcnt vmcnt(56)
    v_and_b32_dpp v16, v35, v8 row_newbcast:0 row_mask:0xf bank_mask:0xf
    v_and_b32_dpp v17, v35, v9 row_newbcast:0 row_mask:0xf bank_mask:0xf
    v_and_b32_dpp v18, v35, v10 row_newbcast:0 row_mask:0xf bank_mask:0xf
    v_and_b32_dpp v19, v35, v11 row_newbcast:0 row_mask:0xf bank_mask:0xf
    v_and_b32_dpp v20, v35, v8 row_newbcast:8 row_mask:0xf bank_mask:0xf
    v_and_b32_dpp v21, v35, v9 row_newbcast:8 row_mask:0xf bank_mask:0xf
    v_and_b32_dpp v22, v35, v10 row_newbcast:8 row_mask:0xf bank_mask:0xf
    v_and_b32_dpp v23, v35, v11 row_newbcast:8 row_mask:0xf bank_mask:0xf
    v_mfma_f32_16x16x32_bf16 v[12:15], v[16:19], a[80:83], v[12:15]
    v_and_b32_dpp v16, v35, v8 row_newbcast:4 row_mask:0xf bank_mask:0xf
    v_and_b32_dpp v17, v35, v9 row_newbcast:4 row_mask:0xf bank_mask:0xf
    v_and_b32_dpp v18, v35, v10 row_newbcast:4 row_mask:0xf bank_mask:0xf
    v_and_b32_dpp v19, v35, v11 row_newbcast:4 row_mask:0xf bank_mask:0xf
    v_mfma_f32_16x16x32_bf16 v[12:15], v[20:23], a[84:87], v[12:15]
    v_and_b32_dpp v20, v35, v8 row_newbcast:12 row_mask:0xf bank_mask:0xf
    v_and_b32_dpp v21, v35, v9 row_newbcast:12 row_mask:0xf bank_mask:0xf
    v_and_b32_dpp v22, v35, v10 row_newbcast:12 row_mask:0xf bank_mask:0xf
    v_and_b32_dpp v23, v35, v11 row_newbcast:12 row_mask:0xf bank_mask:0xf
    v_mfma_f32_16x16x32_bf16 v[12:15], v[16:19], a[88:91], v[12:15]
    s_nop 0
    v_mfma_f32_16x16x32_bf16 v[12:15], v[20:23], a[92:95], v[12:15]
    s_waitcnt vmcnt(52)
    v_dot2_f32_bf16 v28, v160, v4, 0
    v_dot2_f32_bf16 v29, v164, v4, 0
    v_dot2_f32_bf16 v30, v168, v4, 0
    v_dot2_f32_bf16 v31, v172, v4, 0
    v_dot2c_f32_bf16 v28, v161, v5
    v_dot2c_f32_bf16 v29, v165, v5
    v_dot2c_f32_bf16 v30, v169, v5
    v_dot2c_f32_bf16 v31, v173, v5
    v_dot2c_f32_bf16 v28, v162, v6
    v_dot2c_f32_bf16 v29, v166, v6
    v_dot2c_f32_bf16 v30, v170, v6
    v_dot2c_f32_bf16 v31, v174, v6
    v_dot2c_f32_bf16 v28, v163, v7
    v_dot2c_f32_bf16 v29, v167, v7
    v_dot2c_f32_bf16 v30, v171, v7
    v_dot2c_f32_bf16 v31, v175, v7
    v_add_f32_dpp v32, v28, v28 row_ror:8 row_mask:0xf bank_mask:0x3
    s_nop 0
    v_add_f32_dpp v33, v30, v30 row_ror:8 row_mask:0xf bank_mask:0x3
    v_add_f32_dpp v32, v29, v29 row_ror:8 row_mask:0xf bank_mask:0xc
    v_add_f32_dpp v33, v31, v31 row_ror:8 row_mask:0xf bank_mask:0xc
    s_nop 0
    v_add_f32_dpp v34, v32, v32 row_shl:4 row_mask:0xf bank_mask:0x5
    v_add_f32_dpp v34, v33, v33 row_shr:4 row_mask:0xf bank_mask:0xa
    s_nop 1
    v_add_f32_dpp v34, v34, v34 quad_perm:[2,3,0,1] row_mask:0xf bank_mask:0xf
    s_nop 1
    v_add_f32_dpp v34, v34, v34 quad_perm:[1,0,3,2] row_mask:0xf bank_mask:0xf
    v_cvt_pk_bf16_f32 v36, v34, v34
    v_and_b32 v34, 0xffff0000, v36
    v_mul_f32 v34, 0x3db504f3, v34
    v_cvt_pk_bf16_f32 v36, v34, v34
    v_and_b32 v34, 0xffff0000, v36
    s_nop 1
    v_max_f32_dpp v36, v34, v34 row_ror:4 row_mask:0xf bank_mask:0xf
    s_nop 1
    v_max_f32_dpp v36, v36, v36 row_ror:8 row_mask:0xf bank_mask:0xf
    v_mov_b32 v37, v36
    s_nop 1
    v_permlane16_swap_b32 v36, v37
    v_max_f32 v36, v36, v37
    v_mov_b32 v37, v36
    s_nop 1
    v_permlane32_swap_b32 v36, v37
    v_max_f32 v36, v36, v37
    v_max_f32 v36, v36, v24
    v_sub_f32 v37, v34, v36
    v_sub_f32 v38, v24, v36
    v_mul_f32 v37, 0x3fb8aa3b, v37
    v_mul_f32 v38, 0x3fb8aa3b, v38
    v_exp_f32 v37, v37
    v_exp_f32 v26, v38
    v_mov_b32 v24, v36
    v_cvt_pk_bf16_f32 v35, v37, v37
    v_fma_f32 v25, v25, v26, v37
    v_mul_f32 v12, v12, v26
    v_mul_f32 v13, v13, v26
    v_mul_f32 v14, v14, v26
    v_mul_f32 v15, v15, v26
    s_waitcnt vmcnt(48)
    v_and_b32_dpp v16, v35, v8 row_newbcast:0 row_mask:0xf bank_mask:0xf
    v_and_b32_dpp v17, v35, v9 row_newbcast:0 row_mask:0xf bank_mask:0xf
    v_and_b32_dpp v18, v35, v10 row_newbcast:0 row_mask:0xf bank_mask:0xf
    v_and_b32_dpp v19, v35, v11 row_newbcast:0 row_mask:0xf bank_mask:0xf
    v_and_b32_dpp v20, v35, v8 row_newbcast:8 row_mask:0xf bank_mask:0xf
    v_and_b32_dpp v21, v35, v9 row_newbcast:8 row_mask:0xf bank_mask:0xf
    v_and_b32_dpp v22, v35, v10 row_newbcast:8 row_mask:0xf bank_mask:0xf
    v_and_b32_dpp v23, v35, v11 row_newbcast:8 row_mask:0xf bank_mask:0xf
    v_mfma_f32_16x16x32_bf16 v[12:15], v[16:19], a[96:99], v[12:15]
    v_and_b32_dpp v16, v35, v8 row_newbcast:4 row_mask:0xf bank_mask:0xf
    v_and_b32_dpp v17, v35, v9 row_newbcast:4 row_mask:0xf bank_mask:0xf
    v_and_b32_dpp v18, v35, v10 row_newbcast:4 row_mask:0xf bank_mask:0xf
    v_and_b32_dpp v19, v35, v11 row_newbcast:4 row_mask:0xf bank_mask:0xf
    v_mfma_f32_16x16x32_bf16 v[12:15], v[20:23], a[100:103], v[12:15]
    v_and_b32_dpp v20, v35, v8 row_newbcast:12 row_mask:0xf bank_mask:0xf
    v_and_b32_dpp v21, v35, v9 row_newbcast:12 row_mask:0xf bank_mask:0xf
    v_and_b32_dpp v22, v35, v10 row_newbcast:12 row_mask:0xf bank_mask:0xf
    v_and_b32_dpp v23, v35, v11 row_newbcast:12 row_mask:0xf bank_mask:0xf
    v_mfma_f32_16x16x32_bf16 v[12:15], v[16:19], a[104:107], v[12:15]
    s_nop 0
    v_mfma_f32_16x16x32_bf16 v[12:15], v[20:23], a[108:111], v[12:15]
    s_waitcnt vmcnt(44)
    v_dot2_f32_bf16 v28, v176, v4, 0
    v_dot2_f32_bf16 v29, v180, v4, 0
    v_dot2_f32_bf16 v30, v184, v4, 0
    v_dot2_f32_bf16 v31, v188, v4, 0
    v_dot2c_f32_bf16 v28, v177, v5
    v_dot2c_f32_bf16 v29, v181, v5
    v_dot2c_f32_bf16 v30, v185, v5
    v_dot2c_f32_bf16 v31, v189, v5
    v_dot2c_f32_bf16 v28, v178, v6
    v_dot2c_f32_bf16 v29, v182, v6
    v_dot2c_f32_bf16 v30, v186, v6
    v_dot2c_f32_bf16 v31, v190, v6
    v_dot2c_f32_bf16 v28, v179, v7
    v_dot2c_f32_bf16 v29, v183, v7
    v_dot2c_f32_bf16 v30, v187, v7
    v_dot2c_f32_bf16 v31, v191, v7
    v_add_f32_dpp v32, v28, v28 row_ror:8 row_mask:0xf bank_mask:0x3
    s_nop 0
    v_add_f32_dpp v33, v30, v30 row_ror:8 row_mask:0xf bank_mask:0x3
    v_add_f32_dpp v32, v29, v29 row_ror:8 row_mask:0xf bank_mask:0xc
    v_add_f32_dpp v33, v31, v31 row_ror:8 row_mask:0xf bank_mask:0xc
    s_nop 0
    v_add_f32_dpp v34, v32, v32 row_shl:4 row_mask:0xf bank_mask:0x5
    v_add_f32_dpp v34, v33, v33 row_shr:4 row_mask:0xf bank_mask:0xa
    s_nop 1
    v_add_f32_dpp v34, v34, v34 quad_perm:[2,3,0,1] row_mask:0xf bank_mask:0xf
    s_nop 1
    v_add_f32_dpp v34, v34, v34 quad_perm:[1,0,3,2] row_mask:0xf bank_mask:0xf
    v_cvt_pk_bf16_f32 v36, v34, v34
    v_and_b32 v34, 0xffff0000, v36
    v_mul_f32 v34, 0x3db504f3, v34
    v_cvt_pk_bf16_f32 v36, v34, v34
    v_and_b32 v34, 0xffff0000, v36
    s_nop 1
    v_max_f32_dpp v36, v34, v34 row_ror:4 row_mask:0xf bank_mask:0xf
    s_nop 1
    v_max_f32_dpp v36, v36, v36 row_ror:8 row_mask:0xf bank_mask:0xf
    v_mov_b32 v37, v36
    s_nop 1
    v_permlane16_swap_b32 v36, v37
    v_max_f32 v36, v36, v37
    v_mov_b32 v37, v36
    s_nop 1
    v_permlane32_swap_b32 v36, v37
    v_max_f32 v36, v36, v37
    v_max_f32 v36, v36, v24
    v_sub_f32 v37, v34, v36
    v_sub_f32 v38, v24, v36
    v_mul_f32 v37, 0x3fb8aa3b, v37
    v_mul_f32 v38, 0x3fb8aa3b, v38
    v_exp_f32 v37, v37
    v_exp_f32 v26, v38
    v_mov_b32 v24, v36
    v_cvt_pk_bf16_f32 v35, v37, v37
    v_fma_f32 v25, v25, v26, v37
    v_mul_f32 v12, v12, v26
    v_mul_f32 v13, v13, v26
    v_mul_f32 v14, v14, v26
    v_mul_f32 v15, v15, v26
    s_waitcnt vmcnt(40)
    v_and_b32_dpp v16, v35, v8 row_newbcast:0 row_mask:0xf bank_mask:0xf
    v_and_b32_dpp v17, v35, v9 row_newbcast:0 row_mask:0xf bank_mask:0xf
    v_and_b32_dpp v18, v35, v10 row_newbcast:0 row_mask:0xf bank_mask:0xf
    v_and_b32_dpp v19, v35, v11 row_newbcast:0 row_mask:0xf bank_mask:0xf
    v_and_b32_dpp v20, v35, v8 row_newbcast:8 row_mask:0xf bank_mask:0xf
    v_and_b32_dpp v21, v35, v9 row_newbcast:8 row_mask:0xf bank_mask:0xf
    v_and_b32_dpp v22, v35, v10 row_newbcast:8 row_mask:0xf bank_mask:0xf
    v_and_b32_dpp v23, v35, v11 row_newbcast:8 row_mask:0xf bank_mask:0xf
    v_mfma_f32_16x16x32_bf16 v[12:15], v[16:19], a[112:115], v[12:15]
    v_and_b32_dpp v16, v35, v8 row_newbcast:4 row_mask:0xf bank_mask:0xf
    v_and_b32_dpp v17, v35, v9 row_newbcast:4 row_mask:0xf bank_mask:0xf
    v_and_b32_dpp v18, v35, v10 row_newbcast:4 row_mask:0xf bank_mask:0xf
    v_and_b32_dpp v19, v35, v11 row_newbcast:4 row_mask:0xf bank_mask:0xf
    v_mfma_f32_16x16x32_bf16 v[12:15], v[20:23], a[116:119], v[12:15]
    v_and_b32_dpp v20, v35, v8 row_newbcast:12 row_mask:0xf bank_mask:0xf
    v_and_b32_dpp v21, v35, v9 row_newbcast:12 row_mask:0xf bank_mask:0xf
    v_and_b32_dpp v22, v35, v10 row_newbcast:12 row_mask:0xf bank_mask:0xf
    v_and_b32_dpp v23, v35, v11 row_newbcast:12 row_mask:0xf bank_mask:0xf
    v_mfma_f32_16x16x32_bf16 v[12:15], v[16:19], a[120:123], v[12:15]
    s_nop 0
    v_mfma_f32_16x16x32_bf16 v[12:15], v[20:23], a[124:127], v[12:15]
    s_add_u32 s8, s7, 1490944
    s_waitcnt vmcnt(15)
    buffer_load_dwordx4 v[80:83], v0, s[44:47], s8 offen offset:0 nt
    s_waitcnt vmcnt(15)
    buffer_load_dwordx4 v[84:87], v0, s[44:47], s8 offen offset:1024 nt
    s_waitcnt vmcnt(15)
    buffer_load_dwordx4 v[88:91], v0, s[44:47], s8 offen offset:2048 nt
    s_waitcnt vmcnt(15)
    buffer_load_dwordx4 v[92:95], v0, s[44:47], s8 offen offset:3072 nt
    s_waitcnt vmcnt(15)
    buffer_load_dwordx4 a[16:19], v0, s[48:51], s8 offen offset:0 nt
    s_waitcnt vmcnt(15)
    buffer_load_dwordx4 a[20:23], v0, s[48:51], s8 offen offset:1024 nt
    s_waitcnt vmcnt(15)
    buffer_load_dwordx4 a[24:27], v0, s[48:51], s8 offen offset:2048 nt
    s_waitcnt vmcnt(15)
    buffer_load_dwordx4 a[28:31], v0, s[48:51], s8 offen offset:3072 nt
    s_waitcnt vmcnt(44)
    v_dot2_f32_bf16 v28, v192, v4, 0
    v_dot2_f32_bf16 v29, v196, v4, 0
    v_dot2_f32_bf16 v30, v200, v4, 0
    v_dot2_f32_bf16 v31, v204, v4, 0
    v_dot2c_f32_bf16 v28, v193, v5
    v_dot2c_f32_bf16 v29, v197, v5
    v_dot2c_f32_bf16 v30, v201, v5
    v_dot2c_f32_bf16 v31, v205, v5
    v_dot2c_f32_bf16 v28, v194, v6
    v_dot2c_f32_bf16 v29, v198, v6
    v_dot2c_f32_bf16 v30, v202, v6
    v_dot2c_f32_bf16 v31, v206, v6
    v_dot2c_f32_bf16 v28, v195, v7
    v_dot2c_f32_bf16 v29, v199, v7
    v_dot2c_f32_bf16 v30, v203, v7
    v_dot2c_f32_bf16 v31, v207, v7
    v_add_f32_dpp v32, v28, v28 row_ror:8 row_mask:0xf bank_mask:0x3
    s_nop 0
    v_add_f32_dpp v33, v30, v30 row_ror:8 row_mask:0xf bank_mask:0x3
    v_add_f32_dpp v32, v29, v29 row_ror:8 row_mask:0xf bank_mask:0xc
    v_add_f32_dpp v33, v31, v31 row_ror:8 row_mask:0xf bank_mask:0xc
    s_nop 0
    v_add_f32_dpp v34, v32, v32 row_shl:4 row_mask:0xf bank_mask:0x5
    v_add_f32_dpp v34, v33, v33 row_shr:4 row_mask:0xf bank_mask:0xa
    s_nop 1
    v_add_f32_dpp v34, v34, v34 quad_perm:[2,3,0,1] row_mask:0xf bank_mask:0xf
    s_nop 1
    v_add_f32_dpp v34, v34, v34 quad_perm:[1,0,3,2] row_mask:0xf bank_mask:0xf
    v_cvt_pk_bf16_f32 v36, v34, v34
    v_and_b32 v34, 0xffff0000, v36
    v_mul_f32 v34, 0x3db504f3, v34
    v_cvt_pk_bf16_f32 v36, v34, v34
    v_and_b32 v34, 0xffff0000, v36
    s_nop 1
    v_max_f32_dpp v36, v34, v34 row_ror:4 row_mask:0xf bank_mask:0xf
    s_nop 1
    v_max_f32_dpp v36, v36, v36 row_ror:8 row_mask:0xf bank_mask:0xf
    v_mov_b32 v37, v36
    s_nop 1
    v_permlane16_swap_b32 v36, v37
    v_max_f32 v36, v36, v37
    v_mov_b32 v37, v36
    s_nop 1
    v_permlane32_swap_b32 v36, v37
    v_max_f32 v36, v36, v37
    v_max_f32 v36, v36, v24
    v_sub_f32 v37, v34, v36
    v_sub_f32 v38, v24, v36
    v_mul_f32 v37, 0x3fb8aa3b, v37
    v_mul_f32 v38, 0x3fb8aa3b, v38
    v_exp_f32 v37, v37
    v_exp_f32 v26, v38
    v_mov_b32 v24, v36
    v_cvt_pk_bf16_f32 v35, v37, v37
    v_fma_f32 v25, v25, v26, v37
    v_mul_f32 v12, v12, v26
    v_mul_f32 v13, v13, v26
    v_mul_f32 v14, v14, v26
    v_mul_f32 v15, v15, v26
    s_waitcnt vmcnt(40)
    v_and_b32_dpp v16, v35, v8 row_newbcast:0 row_mask:0xf bank_mask:0xf
    v_and_b32_dpp v17, v35, v9 row_newbcast:0 row_mask:0xf bank_mask:0xf
    v_and_b32_dpp v18, v35, v10 row_newbcast:0 row_mask:0xf bank_mask:0xf
    v_and_b32_dpp v19, v35, v11 row_newbcast:0 row_mask:0xf bank_mask:0xf
    v_and_b32_dpp v20, v35, v8 row_newbcast:8 row_mask:0xf bank_mask:0xf
    v_and_b32_dpp v21, v35, v9 row_newbcast:8 row_mask:0xf bank_mask:0xf
    v_and_b32_dpp v22, v35, v10 row_newbcast:8 row_mask:0xf bank_mask:0xf
    v_and_b32_dpp v23, v35, v11 row_newbcast:8 row_mask:0xf bank_mask:0xf
    v_mfma_f32_16x16x32_bf16 v[12:15], v[16:19], a[128:131], v[12:15]
    v_and_b32_dpp v16, v35, v8 row_newbcast:4 row_mask:0xf bank_mask:0xf
    v_and_b32_dpp v17, v35, v9 row_newbcast:4 row_mask:0xf bank_mask:0xf
    v_and_b32_dpp v18, v35, v10 row_newbcast:4 row_mask:0xf bank_mask:0xf
    v_and_b32_dpp v19, v35, v11 row_newbcast:4 row_mask:0xf bank_mask:0xf
    v_mfma_f32_16x16x32_bf16 v[12:15], v[20:23], a[132:135], v[12:15]
    v_and_b32_dpp v20, v35, v8 row_newbcast:12 row_mask:0xf bank_mask:0xf
    v_and_b32_dpp v21, v35, v9 row_newbcast:12 row_mask:0xf bank_mask:0xf
    v_and_b32_dpp v22, v35, v10 row_newbcast:12 row_mask:0xf bank_mask:0xf
    v_and_b32_dpp v23, v35, v11 row_newbcast:12 row_mask:0xf bank_mask:0xf
    v_mfma_f32_16x16x32_bf16 v[12:15], v[16:19], a[136:139], v[12:15]
    s_nop 0
    v_mfma_f32_16x16x32_bf16 v[12:15], v[20:23], a[140:143], v[12:15]
    s_waitcnt vmcnt(36)
    v_dot2_f32_bf16 v28, v208, v4, 0
    v_dot2_f32_bf16 v29, v212, v4, 0
    v_dot2_f32_bf16 v30, v216, v4, 0
    v_dot2_f32_bf16 v31, v220, v4, 0
    v_dot2c_f32_bf16 v28, v209, v5
    v_dot2c_f32_bf16 v29, v213, v5
    v_dot2c_f32_bf16 v30, v217, v5
    v_dot2c_f32_bf16 v31, v221, v5
    v_dot2c_f32_bf16 v28, v210, v6
    v_dot2c_f32_bf16 v29, v214, v6
    v_dot2c_f32_bf16 v30, v218, v6
    v_dot2c_f32_bf16 v31, v222, v6
    v_dot2c_f32_bf16 v28, v211, v7
    v_dot2c_f32_bf16 v29, v215, v7
    v_dot2c_f32_bf16 v30, v219, v7
    v_dot2c_f32_bf16 v31, v223, v7
    v_add_f32_dpp v32, v28, v28 row_ror:8 row_mask:0xf bank_mask:0x3
    s_nop 0
    v_add_f32_dpp v33, v30, v30 row_ror:8 row_mask:0xf bank_mask:0x3
    v_add_f32_dpp v32, v29, v29 row_ror:8 row_mask:0xf bank_mask:0xc
    v_add_f32_dpp v33, v31, v31 row_ror:8 row_mask:0xf bank_mask:0xc
    s_nop 0
    v_add_f32_dpp v34, v32, v32 row_shl:4 row_mask:0xf bank_mask:0x5
    v_add_f32_dpp v34, v33, v33 row_shr:4 row_mask:0xf bank_mask:0xa
    s_nop 1
    v_add_f32_dpp v34, v34, v34 quad_perm:[2,3,0,1] row_mask:0xf bank_mask:0xf
    s_nop 1
    v_add_f32_dpp v34, v34, v34 quad_perm:[1,0,3,2] row_mask:0xf bank_mask:0xf
    v_cvt_pk_bf16_f32 v36, v34, v34
    v_and_b32 v34, 0xffff0000, v36
    v_mul_f32 v34, 0x3db504f3, v34
    v_cvt_pk_bf16_f32 v36, v34, v34
    v_and_b32 v34, 0xffff0000, v36
    s_nop 1
    v_max_f32_dpp v36, v34, v34 row_ror:4 row_mask:0xf bank_mask:0xf
    s_nop 1
    v_max_f32_dpp v36, v36, v36 row_ror:8 row_mask:0xf bank_mask:0xf
    v_mov_b32 v37, v36
    s_nop 1
    v_permlane16_swap_b32 v36, v37
    v_max_f32 v36, v36, v37
    v_mov_b32 v37, v36
    s_nop 1
    v_permlane32_swap_b32 v36, v37
    v_max_f32 v36, v36, v37
    v_max_f32 v36, v36, v24
    v_sub_f32 v37, v34, v36
    v_sub_f32 v38, v24, v36
    v_mul_f32 v37, 0x3fb8aa3b, v37
    v_mul_f32 v38, 0x3fb8aa3b, v38
    v_exp_f32 v37, v37
    v_exp_f32 v26, v38
    v_mov_b32 v24, v36
    v_cvt_pk_bf16_f32 v35, v37, v37
    v_fma_f32 v25, v25, v26, v37
    v_mul_f32 v12, v12, v26
    v_mul_f32 v13, v13, v26
    v_mul_f32 v14, v14, v26
    v_mul_f32 v15, v15, v26
    s_waitcnt vmcnt(32)
    v_and_b32_dpp v16, v35, v8 row_newbcast:0 row_mask:0xf bank_mask:0xf
    v_and_b32_dpp v17, v35, v9 row_newbcast:0 row_mask:0xf bank_mask:0xf
    v_and_b32_dpp v18, v35, v10 row_newbcast:0 row_mask:0xf bank_mask:0xf
    v_and_b32_dpp v19, v35, v11 row_newbcast:0 row_mask:0xf bank_mask:0xf
    v_and_b32_dpp v20, v35, v8 row_newbcast:8 row_mask:0xf bank_mask:0xf
    v_and_b32_dpp v21, v35, v9 row_newbcast:8 row_mask:0xf bank_mask:0xf
    v_and_b32_dpp v22, v35, v10 row_newbcast:8 row_mask:0xf bank_mask:0xf
    v_and_b32_dpp v23, v35, v11 row_newbcast:8 row_mask:0xf bank_mask:0xf
    v_mfma_f32_16x16x32_bf16 v[12:15], v[16:19], a[144:147], v[12:15]
    v_and_b32_dpp v16, v35, v8 row_newbcast:4 row_mask:0xf bank_mask:0xf
    v_and_b32_dpp v17, v35, v9 row_newbcast:4 row_mask:0xf bank_mask:0xf
    v_and_b32_dpp v18, v35, v10 row_newbcast:4 row_mask:0xf bank_mask:0xf
    v_and_b32_dpp v19, v35, v11 row_newbcast:4 row_mask:0xf bank_mask:0xf
    v_mfma_f32_16x16x32_bf16 v[12:15], v[20:23], a[148:151], v[12:15]
    v_and_b32_dpp v20, v35, v8 row_newbcast:12 row_mask:0xf bank_mask:0xf
    v_and_b32_dpp v21, v35, v9 row_newbcast:12 row_mask:0xf bank_mask:0xf
    v_and_b32_dpp v22, v35, v10 row_newbcast:12 row_mask:0xf bank_mask:0xf
    v_and_b32_dpp v23, v35, v11 row_newbcast:12 row_mask:0xf bank_mask:0xf
    v_mfma_f32_16x16x32_bf16 v[12:15], v[16:19], a[152:155], v[12:15]
    s_nop 0
    v_mfma_f32_16x16x32_bf16 v[12:15], v[20:23], a[156:159], v[12:15]
    s_waitcnt vmcnt(28)
    v_dot2_f32_bf16 v28, v224, v4, 0
    v_dot2_f32_bf16 v29, v228, v4, 0
    v_dot2_f32_bf16 v30, v232, v4, 0
    v_dot2_f32_bf16 v31, v236, v4, 0
    v_dot2c_f32_bf16 v28, v225, v5
    v_dot2c_f32_bf16 v29, v229, v5
    v_dot2c_f32_bf16 v30, v233, v5
    v_dot2c_f32_bf16 v31, v237, v5
    v_dot2c_f32_bf16 v28, v226, v6
    v_dot2c_f32_bf16 v29, v230, v6
    v_dot2c_f32_bf16 v30, v234, v6
    v_dot2c_f32_bf16 v31, v238, v6
    v_dot2c_f32_bf16 v28, v227, v7
    v_dot2c_f32_bf16 v29, v231, v7
    v_dot2c_f32_bf16 v30, v235, v7
    v_dot2c_f32_bf16 v31, v239, v7
    v_add_f32_dpp v32, v28, v28 row_ror:8 row_mask:0xf bank_mask:0x3
    s_nop 0
    v_add_f32_dpp v33, v30, v30 row_ror:8 row_mask:0xf bank_mask:0x3
    v_add_f32_dpp v32, v29, v29 row_ror:8 row_mask:0xf bank_mask:0xc
    v_add_f32_dpp v33, v31, v31 row_ror:8 row_mask:0xf bank_mask:0xc
    s_nop 0
    v_add_f32_dpp v34, v32, v32 row_shl:4 row_mask:0xf bank_mask:0x5
    v_add_f32_dpp v34, v33, v33 row_shr:4 row_mask:0xf bank_mask:0xa
    s_nop 1
    v_add_f32_dpp v34, v34, v34 quad_perm:[2,3,0,1] row_mask:0xf bank_mask:0xf
    s_nop 1
    v_add_f32_dpp v34, v34, v34 quad_perm:[1,0,3,2] row_mask:0xf bank_mask:0xf
    v_cvt_pk_bf16_f32 v36, v34, v34
    v_and_b32 v34, 0xffff0000, v36
    v_mul_f32 v34, 0x3db504f3, v34
    v_cvt_pk_bf16_f32 v36, v34, v34
    v_and_b32 v34, 0xffff0000, v36
    s_nop 1
    v_max_f32_dpp v36, v34, v34 row_ror:4 row_mask:0xf bank_mask:0xf
    s_nop 1
    v_max_f32_dpp v36, v36, v36 row_ror:8 row_mask:0xf bank_mask:0xf
    v_mov_b32 v37, v36
    s_nop 1
    v_permlane16_swap_b32 v36, v37
    v_max_f32 v36, v36, v37
    v_mov_b32 v37, v36
    s_nop 1
    v_permlane32_swap_b32 v36, v37
    v_max_f32 v36, v36, v37
    v_max_f32 v36, v36, v24
    v_sub_f32 v37, v34, v36
    v_sub_f32 v38, v24, v36
    v_mul_f32 v37, 0x3fb8aa3b, v37
    v_mul_f32 v38, 0x3fb8aa3b, v38
    v_exp_f32 v37, v37
    v_exp_f32 v26, v38
    v_mov_b32 v24, v36
    v_cvt_pk_bf16_f32 v35, v37, v37
    v_fma_f32 v25, v25, v26, v37
    v_mul_f32 v12, v12, v26
    v_mul_f32 v13, v13, v26
    v_mul_f32 v14, v14, v26
    v_mul_f32 v15, v15, v26
    s_waitcnt vmcnt(24)
    v_and_b32_dpp v16, v35, v8 row_newbcast:0 row_mask:0xf bank_mask:0xf
    v_and_b32_dpp v17, v35, v9 row_newbcast:0 row_mask:0xf bank_mask:0xf
    v_and_b32_dpp v18, v35, v10 row_newbcast:0 row_mask:0xf bank_mask:0xf
    v_and_b32_dpp v19, v35, v11 row_newbcast:0 row_mask:0xf bank_mask:0xf
    v_and_b32_dpp v20, v35, v8 row_newbcast:8 row_mask:0xf bank_mask:0xf
    v_and_b32_dpp v21, v35, v9 row_newbcast:8 row_mask:0xf bank_mask:0xf
    v_and_b32_dpp v22, v35, v10 row_newbcast:8 row_mask:0xf bank_mask:0xf
    v_and_b32_dpp v23, v35, v11 row_newbcast:8 row_mask:0xf bank_mask:0xf
    v_mfma_f32_16x16x32_bf16 v[12:15], v[16:19], a[160:163], v[12:15]
    v_and_b32_dpp v16, v35, v8 row_newbcast:4 row_mask:0xf bank_mask:0xf
    v_and_b32_dpp v17, v35, v9 row_newbcast:4 row_mask:0xf bank_mask:0xf
    v_and_b32_dpp v18, v35, v10 row_newbcast:4 row_mask:0xf bank_mask:0xf
    v_and_b32_dpp v19, v35, v11 row_newbcast:4 row_mask:0xf bank_mask:0xf
    v_mfma_f32_16x16x32_bf16 v[12:15], v[20:23], a[164:167], v[12:15]
    v_and_b32_dpp v20, v35, v8 row_newbcast:12 row_mask:0xf bank_mask:0xf
    v_and_b32_dpp v21, v35, v9 row_newbcast:12 row_mask:0xf bank_mask:0xf
    v_and_b32_dpp v22, v35, v10 row_newbcast:12 row_mask:0xf bank_mask:0xf
    v_and_b32_dpp v23, v35, v11 row_newbcast:12 row_mask:0xf bank_mask:0xf
    v_mfma_f32_16x16x32_bf16 v[12:15], v[16:19], a[168:171], v[12:15]
    s_nop 0
    v_mfma_f32_16x16x32_bf16 v[12:15], v[20:23], a[172:175], v[12:15]
    s_waitcnt vmcnt(20)
    v_dot2_f32_bf16 v28, v240, v4, 0
    v_dot2_f32_bf16 v29, v244, v4, 0
    v_dot2_f32_bf16 v30, v248, v4, 0
    v_dot2_f32_bf16 v31, v252, v4, 0
    v_dot2c_f32_bf16 v28, v241, v5
    v_dot2c_f32_bf16 v29, v245, v5
    v_dot2c_f32_bf16 v30, v249, v5
    v_dot2c_f32_bf16 v31, v253, v5
    v_dot2c_f32_bf16 v28, v242, v6
    v_dot2c_f32_bf16 v29, v246, v6
    v_dot2c_f32_bf16 v30, v250, v6
    v_dot2c_f32_bf16 v31, v254, v6
    v_dot2c_f32_bf16 v28, v243, v7
    v_dot2c_f32_bf16 v29, v247, v7
    v_dot2c_f32_bf16 v30, v251, v7
    v_dot2c_f32_bf16 v31, v255, v7
    v_add_f32_dpp v32, v28, v28 row_ror:8 row_mask:0xf bank_mask:0x3
    s_nop 0
    v_add_f32_dpp v33, v30, v30 row_ror:8 row_mask:0xf bank_mask:0x3
    v_add_f32_dpp v32, v29, v29 row_ror:8 row_mask:0xf bank_mask:0xc
    v_add_f32_dpp v33, v31, v31 row_ror:8 row_mask:0xf bank_mask:0xc
    s_nop 0
    v_add_f32_dpp v34, v32, v32 row_shl:4 row_mask:0xf bank_mask:0x5
    v_add_f32_dpp v34, v33, v33 row_shr:4 row_mask:0xf bank_mask:0xa
    s_nop 1
    v_add_f32_dpp v34, v34, v34 quad_perm:[2,3,0,1] row_mask:0xf bank_mask:0xf
    s_nop 1
    v_add_f32_dpp v34, v34, v34 quad_perm:[1,0,3,2] row_mask:0xf bank_mask:0xf
    v_cvt_pk_bf16_f32 v36, v34, v34
    v_and_b32 v34, 0xffff0000, v36
    v_mul_f32 v34, 0x3db504f3, v34
    v_cvt_pk_bf16_f32 v36, v34, v34
    v_and_b32 v34, 0xffff0000, v36
    s_nop 1
    v_max_f32_dpp v36, v34, v34 row_ror:4 row_mask:0xf bank_mask:0xf
    s_nop 1
    v_max_f32_dpp v36, v36, v36 row_ror:8 row_mask:0xf bank_mask:0xf
    v_mov_b32 v37, v36
    s_nop 1
    v_permlane16_swap_b32 v36, v37
    v_max_f32 v36, v36, v37
    v_mov_b32 v37, v36
    s_nop 1
    v_permlane32_swap_b32 v36, v37
    v_max_f32 v36, v36, v37
    v_max_f32 v36, v36, v24
    v_sub_f32 v37, v34, v36
    v_sub_f32 v38, v24, v36
    v_mul_f32 v37, 0x3fb8aa3b, v37
    v_mul_f32 v38, 0x3fb8aa3b, v38
    v_exp_f32 v37, v37
    v_exp_f32 v26, v38
    v_mov_b32 v24, v36
    v_cvt_pk_bf16_f32 v35, v37, v37
    v_fma_f32 v25, v25, v26, v37
    v_mul_f32 v12, v12, v26
    v_mul_f32 v13, v13, v26
    v_mul_f32 v14, v14, v26
    v_mul_f32 v15, v15, v26
    s_waitcnt vmcnt(16)
    v_and_b32_dpp v16, v35, v8 row_newbcast:0 row_mask:0xf bank_mask:0xf
    v_and_b32_dpp v17, v35, v9 row_newbcast:0 row_mask:0xf bank_mask:0xf
    v_and_b32_dpp v18, v35, v10 row_newbcast:0 row_mask:0xf bank_mask:0xf
    v_and_b32_dpp v19, v35, v11 row_newbcast:0 row_mask:0xf bank_mask:0xf
    v_and_b32_dpp v20, v35, v8 row_newbcast:8 row_mask:0xf bank_mask:0xf
    v_and_b32_dpp v21, v35, v9 row_newbcast:8 row_mask:0xf bank_mask:0xf
    v_and_b32_dpp v22, v35, v10 row_newbcast:8 row_mask:0xf bank_mask:0xf
    v_and_b32_dpp v23, v35, v11 row_newbcast:8 row_mask:0xf bank_mask:0xf
    v_mfma_f32_16x16x32_bf16 v[12:15], v[16:19], a[176:179], v[12:15]
    v_and_b32_dpp v16, v35, v8 row_newbcast:4 row_mask:0xf bank_mask:0xf
    v_and_b32_dpp v17, v35, v9 row_newbcast:4 row_mask:0xf bank_mask:0xf
    v_and_b32_dpp v18, v35, v10 row_newbcast:4 row_mask:0xf bank_mask:0xf
    v_and_b32_dpp v19, v35, v11 row_newbcast:4 row_mask:0xf bank_mask:0xf
    v_mfma_f32_16x16x32_bf16 v[12:15], v[20:23], a[180:183], v[12:15]
    v_and_b32_dpp v20, v35, v8 row_newbcast:12 row_mask:0xf bank_mask:0xf
    v_and_b32_dpp v21, v35, v9 row_newbcast:12 row_mask:0xf bank_mask:0xf
    v_and_b32_dpp v22, v35, v10 row_newbcast:12 row_mask:0xf bank_mask:0xf
    v_and_b32_dpp v23, v35, v11 row_newbcast:12 row_mask:0xf bank_mask:0xf
    v_mfma_f32_16x16x32_bf16 v[12:15], v[16:19], a[184:187], v[12:15]
    s_nop 0
    v_mfma_f32_16x16x32_bf16 v[12:15], v[20:23], a[188:191], v[12:15]
    s_add_u32 s8, s7, 1605632
    s_waitcnt vmcnt(15)
    buffer_load_dwordx4 v[96:99], v0, s[44:47], s8 offen offset:0 nt
    s_waitcnt vmcnt(15)
    buffer_load_dwordx4 v[100:103], v0, s[44:47], s8 offen offset:1024 nt
    s_waitcnt vmcnt(15)
    buffer_load_dwordx4 v[104:107], v0, s[44:47], s8 offen offset:2048 nt
    s_waitcnt vmcnt(15)
    buffer_load_dwordx4 v[108:111], v0, s[44:47], s8 offen offset:3072 nt
    s_waitcnt vmcnt(15)
    buffer_load_dwordx4 a[32:35], v0, s[48:51], s8 offen offset:0 nt
    s_waitcnt vmcnt(15)
    buffer_load_dwordx4 a[36:39], v0, s[48:51], s8 offen offset:1024 nt
    s_waitcnt vmcnt(15)
    buffer_load_dwordx4 a[40:43], v0, s[48:51], s8 offen offset:2048 nt
    s_waitcnt vmcnt(15)
    buffer_load_dwordx4 a[44:47], v0, s[48:51], s8 offen offset:3072 nt
    s_waitcnt vmcnt(20)
    v_dot2_f32_bf16 v28, v64, v4, 0
    v_dot2_f32_bf16 v29, v68, v4, 0
    v_dot2_f32_bf16 v30, v72, v4, 0
    v_dot2_f32_bf16 v31, v76, v4, 0
    v_dot2c_f32_bf16 v28, v65, v5
    v_dot2c_f32_bf16 v29, v69, v5
    v_dot2c_f32_bf16 v30, v73, v5
    v_dot2c_f32_bf16 v31, v77, v5
    v_dot2c_f32_bf16 v28, v66, v6
    v_dot2c_f32_bf16 v29, v70, v6
    v_dot2c_f32_bf16 v30, v74, v6
    v_dot2c_f32_bf16 v31, v78, v6
    v_dot2c_f32_bf16 v28, v67, v7
    v_dot2c_f32_bf16 v29, v71, v7
    v_dot2c_f32_bf16 v30, v75, v7
    v_dot2c_f32_bf16 v31, v79, v7
    v_add_f32_dpp v32, v28, v28 row_ror:8 row_mask:0xf bank_mask:0x3
    s_nop 0
    v_add_f32_dpp v33, v30, v30 row_ror:8 row_mask:0xf bank_mask:0x3
    v_add_f32_dpp v32, v29, v29 row_ror:8 row_mask:0xf bank_mask:0xc
    v_add_f32_dpp v33, v31, v31 row_ror:8 row_mask:0xf bank_mask:0xc
    s_nop 0
    v_add_f32_dpp v34, v32, v32 row_shl:4 row_mask:0xf bank_mask:0x5
    v_add_f32_dpp v34, v33, v33 row_shr:4 row_mask:0xf bank_mask:0xa
    s_nop 1
    v_add_f32_dpp v34, v34, v34 quad_perm:[2,3,0,1] row_mask:0xf bank_mask:0xf
    s_nop 1
    v_add_f32_dpp v34, v34, v34 quad_perm:[1,0,3,2] row_mask:0xf bank_mask:0xf
    v_cvt_pk_bf16_f32 v36, v34, v34
    v_and_b32 v34, 0xffff0000, v36
    v_mul_f32 v34, 0x3db504f3, v34
    v_cvt_pk_bf16_f32 v36, v34, v34
    v_and_b32 v34, 0xffff0000, v36
    s_nop 1
    v_max_f32_dpp v36, v34, v34 row_ror:4 row_mask:0xf bank_mask:0xf
    s_nop 1
    v_max_f32_dpp v36, v36, v36 row_ror:8 row_mask:0xf bank_mask:0xf
    v_mov_b32 v37, v36
    s_nop 1
    v_permlane16_swap_b32 v36, v37
    v_max_f32 v36, v36, v37
    v_mov_b32 v37, v36
    s_nop 1
    v_permlane32_swap_b32 v36, v37
    v_max_f32 v36, v36, v37
    v_max_f32 v36, v36, v24
    v_sub_f32 v37, v34, v36
    v_sub_f32 v38, v24, v36
    v_mul_f32 v37, 0x3fb8aa3b, v37
    v_mul_f32 v38, 0x3fb8aa3b, v38
    v_exp_f32 v37, v37
    v_exp_f32 v26, v38
    v_mov_b32 v24, v36
    v_cvt_pk_bf16_f32 v35, v37, v37
    v_fma_f32 v25, v25, v26, v37
    v_mul_f32 v12, v12, v26
    v_mul_f32 v13, v13, v26
    v_mul_f32 v14, v14, v26
    v_mul_f32 v15, v15, v26
    s_waitcnt vmcnt(16)
    v_and_b32_dpp v16, v35, v8 row_newbcast:0 row_mask:0xf bank_mask:0xf
    v_and_b32_dpp v17, v35, v9 row_newbcast:0 row_mask:0xf bank_mask:0xf
    v_and_b32_dpp v18, v35, v10 row_newbcast:0 row_mask:0xf bank_mask:0xf
    v_and_b32_dpp v19, v35, v11 row_newbcast:0 row_mask:0xf bank_mask:0xf
    v_and_b32_dpp v20, v35, v8 row_newbcast:8 row_mask:0xf bank_mask:0xf
    v_and_b32_dpp v21, v35, v9 row_newbcast:8 row_mask:0xf bank_mask:0xf
    v_and_b32_dpp v22, v35, v10 row_newbcast:8 row_mask:0xf bank_mask:0xf
    v_and_b32_dpp v23, v35, v11 row_newbcast:8 row_mask:0xf bank_mask:0xf
    v_mfma_f32_16x16x32_bf16 v[12:15], v[16:19], a[0:3], v[12:15]
    v_and_b32_dpp v16, v35, v8 row_newbcast:4 row_mask:0xf bank_mask:0xf
    v_and_b32_dpp v17, v35, v9 row_newbcast:4 row_mask:0xf bank_mask:0xf
    v_and_b32_dpp v18, v35, v10 row_newbcast:4 row_mask:0xf bank_mask:0xf
    v_and_b32_dpp v19, v35, v11 row_newbcast:4 row_mask:0xf bank_mask:0xf
    v_mfma_f32_16x16x32_bf16 v[12:15], v[20:23], a[4:7], v[12:15]
    v_and_b32_dpp v20, v35, v8 row_newbcast:12 row_mask:0xf bank_mask:0xf
    v_and_b32_dpp v21, v35, v9 row_newbcast:12 row_mask:0xf bank_mask:0xf
    v_and_b32_dpp v22, v35, v10 row_newbcast:12 row_mask:0xf bank_mask:0xf
    v_and_b32_dpp v23, v35, v11 row_newbcast:12 row_mask:0xf bank_mask:0xf
    v_mfma_f32_16x16x32_bf16 v[12:15], v[16:19], a[8:11], v[12:15]
    s_nop 0
    v_mfma_f32_16x16x32_bf16 v[12:15], v[20:23], a[12:15], v[12:15]
    s_add_u32 s8, s7, 1720320
    s_waitcnt vmcnt(15)
    buffer_load_dwordx4 v[112:115], v0, s[44:47], s8 offen offset:0 nt
    s_waitcnt vmcnt(15)
    buffer_load_dwordx4 v[116:119], v0, s[44:47], s8 offen offset:1024 nt
    s_waitcnt vmcnt(15)
    buffer_load_dwordx4 v[120:123], v0, s[44:47], s8 offen offset:2048 nt
    s_waitcnt vmcnt(15)
    buffer_load_dwordx4 v[124:127], v0, s[44:47], s8 offen offset:3072 nt
    s_waitcnt vmcnt(15)
    buffer_load_dwordx4 a[48:51], v0, s[48:51], s8 offen offset:0 nt
    s_waitcnt vmcnt(15)
    buffer_load_dwordx4 a[52:55], v0, s[48:51], s8 offen offset:1024 nt
    s_waitcnt vmcnt(15)
    buffer_load_dwordx4 a[56:59], v0, s[48:51], s8 offen offset:2048 nt
    s_waitcnt vmcnt(15)
    buffer_load_dwordx4 a[60:63], v0, s[48:51], s8 offen offset:3072 nt
    s_waitcnt vmcnt(20)
    v_dot2_f32_bf16 v28, v80, v4, 0
    v_dot2_f32_bf16 v29, v84, v4, 0
    v_dot2_f32_bf16 v30, v88, v4, 0
    v_dot2_f32_bf16 v31, v92, v4, 0
    v_dot2c_f32_bf16 v28, v81, v5
    v_dot2c_f32_bf16 v29, v85, v5
    v_dot2c_f32_bf16 v30, v89, v5
    v_dot2c_f32_bf16 v31, v93, v5
    v_dot2c_f32_bf16 v28, v82, v6
    v_dot2c_f32_bf16 v29, v86, v6
    v_dot2c_f32_bf16 v30, v90, v6
    v_dot2c_f32_bf16 v31, v94, v6
    v_dot2c_f32_bf16 v28, v83, v7
    v_dot2c_f32_bf16 v29, v87, v7
    v_dot2c_f32_bf16 v30, v91, v7
    v_dot2c_f32_bf16 v31, v95, v7
    v_add_f32_dpp v32, v28, v28 row_ror:8 row_mask:0xf bank_mask:0x3
    s_nop 0
    v_add_f32_dpp v33, v30, v30 row_ror:8 row_mask:0xf bank_mask:0x3
    v_add_f32_dpp v32, v29, v29 row_ror:8 row_mask:0xf bank_mask:0xc
    v_add_f32_dpp v33, v31, v31 row_ror:8 row_mask:0xf bank_mask:0xc
    s_nop 0
    v_add_f32_dpp v34, v32, v32 row_shl:4 row_mask:0xf bank_mask:0x5
    v_add_f32_dpp v34, v33, v33 row_shr:4 row_mask:0xf bank_mask:0xa
    s_nop 1
    v_add_f32_dpp v34, v34, v34 quad_perm:[2,3,0,1] row_mask:0xf bank_mask:0xf
    s_nop 1
    v_add_f32_dpp v34, v34, v34 quad_perm:[1,0,3,2] row_mask:0xf bank_mask:0xf
    v_cvt_pk_bf16_f32 v36, v34, v34
    v_and_b32 v34, 0xffff0000, v36
    v_mul_f32 v34, 0x3db504f3, v34
    v_cvt_pk_bf16_f32 v36, v34, v34
    v_and_b32 v34, 0xffff0000, v36
    s_nop 1
    v_max_f32_dpp v36, v34, v34 row_ror:4 row_mask:0xf bank_mask:0xf
    s_nop 1
    v_max_f32_dpp v36, v36, v36 row_ror:8 row_mask:0xf bank_mask:0xf
    v_mov_b32 v37, v36
    s_nop 1
    v_permlane16_swap_b32 v36, v37
    v_max_f32 v36, v36, v37
    v_mov_b32 v37, v36
    s_nop 1
    v_permlane32_swap_b32 v36, v37
    v_max_f32 v36, v36, v37
    v_max_f32 v36, v36, v24
    v_sub_f32 v37, v34, v36
    v_sub_f32 v38, v24, v36
    v_mul_f32 v37, 0x3fb8aa3b, v37
    v_mul_f32 v38, 0x3fb8aa3b, v38
    v_exp_f32 v37, v37
    v_exp_f32 v26, v38
    v_mov_b32 v24, v36
    v_cvt_pk_bf16_f32 v35, v37, v37
    v_fma_f32 v25, v25, v26, v37
    v_mul_f32 v12, v12, v26
    v_mul_f32 v13, v13, v26
    v_mul_f32 v14, v14, v26
    v_mul_f32 v15, v15, v26
    s_waitcnt vmcnt(16)
    v_and_b32_dpp v16, v35, v8 row_newbcast:0 row_mask:0xf bank_mask:0xf
    v_and_b32_dpp v17, v35, v9 row_newbcast:0 row_mask:0xf bank_mask:0xf
    v_and_b32_dpp v18, v35, v10 row_newbcast:0 row_mask:0xf bank_mask:0xf
    v_and_b32_dpp v19, v35, v11 row_newbcast:0 row_mask:0xf bank_mask:0xf
    v_and_b32_dpp v20, v35, v8 row_newbcast:8 row_mask:0xf bank_mask:0xf
    v_and_b32_dpp v21, v35, v9 row_newbcast:8 row_mask:0xf bank_mask:0xf
    v_and_b32_dpp v22, v35, v10 row_newbcast:8 row_mask:0xf bank_mask:0xf
    v_and_b32_dpp v23, v35, v11 row_newbcast:8 row_mask:0xf bank_mask:0xf
    v_mfma_f32_16x16x32_bf16 v[12:15], v[16:19], a[16:19], v[12:15]
    v_and_b32_dpp v16, v35, v8 row_newbcast:4 row_mask:0xf bank_mask:0xf
    v_and_b32_dpp v17, v35, v9 row_newbcast:4 row_mask:0xf bank_mask:0xf
    v_and_b32_dpp v18, v35, v10 row_newbcast:4 row_mask:0xf bank_mask:0xf
    v_and_b32_dpp v19, v35, v11 row_newbcast:4 row_mask:0xf bank_mask:0xf
    v_mfma_f32_16x16x32_bf16 v[12:15], v[20:23], a[20:23], v[12:15]
    v_and_b32_dpp v20, v35, v8 row_newbcast:12 row_mask:0xf bank_mask:0xf
    v_and_b32_dpp v21, v35, v9 row_newbcast:12 row_mask:0xf bank_mask:0xf
    v_and_b32_dpp v22, v35, v10 row_newbcast:12 row_mask:0xf bank_mask:0xf
    v_and_b32_dpp v23, v35, v11 row_newbcast:12 row_mask:0xf bank_mask:0xf
    v_mfma_f32_16x16x32_bf16 v[12:15], v[16:19], a[24:27], v[12:15]
    s_nop 0
    v_mfma_f32_16x16x32_bf16 v[12:15], v[20:23], a[28:31], v[12:15]
    s_add_u32 s8, s7, 1835008
    s_waitcnt vmcnt(15)
    buffer_load_dwordx4 v[128:131], v0, s[44:47], s8 offen offset:0 nt
    s_waitcnt vmcnt(15)
    buffer_load_dwordx4 v[132:135], v0, s[44:47], s8 offen offset:1024 nt
    s_waitcnt vmcnt(15)
    buffer_load_dwordx4 v[136:139], v0, s[44:47], s8 offen offset:2048 nt
    s_waitcnt vmcnt(15)
    buffer_load_dwordx4 v[140:143], v0, s[44:47], s8 offen offset:3072 nt
    s_waitcnt vmcnt(15)
    buffer_load_dwordx4 a[64:67], v0, s[48:51], s8 offen offset:0 nt
    s_waitcnt vmcnt(15)
    buffer_load_dwordx4 a[68:71], v0, s[48:51], s8 offen offset:1024 nt
    s_waitcnt vmcnt(15)
    buffer_load_dwordx4 a[72:75], v0, s[48:51], s8 offen offset:2048 nt
    s_waitcnt vmcnt(15)
    buffer_load_dwordx4 a[76:79], v0, s[48:51], s8 offen offset:3072 nt
    s_waitcnt vmcnt(20)
    v_dot2_f32_bf16 v28, v96, v4, 0
    v_dot2_f32_bf16 v29, v100, v4, 0
    v_dot2_f32_bf16 v30, v104, v4, 0
    v_dot2_f32_bf16 v31, v108, v4, 0
    v_dot2c_f32_bf16 v28, v97, v5
    v_dot2c_f32_bf16 v29, v101, v5
    v_dot2c_f32_bf16 v30, v105, v5
    v_dot2c_f32_bf16 v31, v109, v5
    v_dot2c_f32_bf16 v28, v98, v6
    v_dot2c_f32_bf16 v29, v102, v6
    v_dot2c_f32_bf16 v30, v106, v6
    v_dot2c_f32_bf16 v31, v110, v6
    v_dot2c_f32_bf16 v28, v99, v7
    v_dot2c_f32_bf16 v29, v103, v7
    v_dot2c_f32_bf16 v30, v107, v7
    v_dot2c_f32_bf16 v31, v111, v7
    v_add_f32_dpp v32, v28, v28 row_ror:8 row_mask:0xf bank_mask:0x3
    s_nop 0
    v_add_f32_dpp v33, v30, v30 row_ror:8 row_mask:0xf bank_mask:0x3
    v_add_f32_dpp v32, v29, v29 row_ror:8 row_mask:0xf bank_mask:0xc
    v_add_f32_dpp v33, v31, v31 row_ror:8 row_mask:0xf bank_mask:0xc
    s_nop 0
    v_add_f32_dpp v34, v32, v32 row_shl:4 row_mask:0xf bank_mask:0x5
    v_add_f32_dpp v34, v33, v33 row_shr:4 row_mask:0xf bank_mask:0xa
    s_nop 1
    v_add_f32_dpp v34, v34, v34 quad_perm:[2,3,0,1] row_mask:0xf bank_mask:0xf
    s_nop 1
    v_add_f32_dpp v34, v34, v34 quad_perm:[1,0,3,2] row_mask:0xf bank_mask:0xf
    v_cvt_pk_bf16_f32 v36, v34, v34
    v_and_b32 v34, 0xffff0000, v36
    v_mul_f32 v34, 0x3db504f3, v34
    v_cvt_pk_bf16_f32 v36, v34, v34
    v_and_b32 v34, 0xffff0000, v36
    s_nop 1
    v_max_f32_dpp v36, v34, v34 row_ror:4 row_mask:0xf bank_mask:0xf
    s_nop 1
    v_max_f32_dpp v36, v36, v36 row_ror:8 row_mask:0xf bank_mask:0xf
    v_mov_b32 v37, v36
    s_nop 1
    v_permlane16_swap_b32 v36, v37
    v_max_f32 v36, v36, v37
    v_mov_b32 v37, v36
    s_nop 1
    v_permlane32_swap_b32 v36, v37
    v_max_f32 v36, v36, v37
    v_max_f32 v36, v36, v24
    v_sub_f32 v37, v34, v36
    v_sub_f32 v38, v24, v36
    v_mul_f32 v37, 0x3fb8aa3b, v37
    v_mul_f32 v38, 0x3fb8aa3b, v38
    v_exp_f32 v37, v37
    v_exp_f32 v26, v38
    v_mov_b32 v24, v36
    v_cvt_pk_bf16_f32 v35, v37, v37
    v_fma_f32 v25, v25, v26, v37
    v_mul_f32 v12, v12, v26
    v_mul_f32 v13, v13, v26
    v_mul_f32 v14, v14, v26
    v_mul_f32 v15, v15, v26
    s_waitcnt vmcnt(16)
    v_and_b32_dpp v16, v35, v8 row_newbcast:0 row_mask:0xf bank_mask:0xf
    v_and_b32_dpp v17, v35, v9 row_newbcast:0 row_mask:0xf bank_mask:0xf
    v_and_b32_dpp v18, v35, v10 row_newbcast:0 row_mask:0xf bank_mask:0xf
    v_and_b32_dpp v19, v35, v11 row_newbcast:0 row_mask:0xf bank_mask:0xf
    v_and_b32_dpp v20, v35, v8 row_newbcast:8 row_mask:0xf bank_mask:0xf
    v_and_b32_dpp v21, v35, v9 row_newbcast:8 row_mask:0xf bank_mask:0xf
    v_and_b32_dpp v22, v35, v10 row_newbcast:8 row_mask:0xf bank_mask:0xf
    v_and_b32_dpp v23, v35, v11 row_newbcast:8 row_mask:0xf bank_mask:0xf
    v_mfma_f32_16x16x32_bf16 v[12:15], v[16:19], a[32:35], v[12:15]
    v_and_b32_dpp v16, v35, v8 row_newbcast:4 row_mask:0xf bank_mask:0xf
    v_and_b32_dpp v17, v35, v9 row_newbcast:4 row_mask:0xf bank_mask:0xf
    v_and_b32_dpp v18, v35, v10 row_newbcast:4 row_mask:0xf bank_mask:0xf
    v_and_b32_dpp v19, v35, v11 row_newbcast:4 row_mask:0xf bank_mask:0xf
    v_mfma_f32_16x16x32_bf16 v[12:15], v[20:23], a[36:39], v[12:15]
    v_and_b32_dpp v20, v35, v8 row_newbcast:12 row_mask:0xf bank_mask:0xf
    v_and_b32_dpp v21, v35, v9 row_newbcast:12 row_mask:0xf bank_mask:0xf
    v_and_b32_dpp v22, v35, v10 row_newbcast:12 row_mask:0xf bank_mask:0xf
    v_and_b32_dpp v23, v35, v11 row_newbcast:12 row_mask:0xf bank_mask:0xf
    v_mfma_f32_16x16x32_bf16 v[12:15], v[16:19], a[40:43], v[12:15]
    s_nop 0
    v_mfma_f32_16x16x32_bf16 v[12:15], v[20:23], a[44:47], v[12:15]
    s_add_u32 s8, s7, 1949696
    s_waitcnt vmcnt(15)
    buffer_load_dwordx4 v[144:147], v0, s[44:47], s8 offen offset:0 nt
    s_waitcnt vmcnt(15)
    buffer_load_dwordx4 v[148:151], v0, s[44:47], s8 offen offset:1024 nt
    s_waitcnt vmcnt(15)
    buffer_load_dwordx4 v[152:155], v0, s[44:47], s8 offen offset:2048 nt
    s_waitcnt vmcnt(15)
    buffer_load_dwordx4 v[156:159], v0, s[44:47], s8 offen offset:3072 nt
    s_waitcnt vmcnt(15)
    buffer_load_dwordx4 a[80:83], v0, s[48:51], s8 offen offset:0 nt
    s_waitcnt vmcnt(15)
    buffer_load_dwordx4 a[84:87], v0, s[48:51], s8 offen offset:1024 nt
    s_waitcnt vmcnt(15)
    buffer_load_dwordx4 a[88:91], v0, s[48:51], s8 offen offset:2048 nt
    s_waitcnt vmcnt(15)
    buffer_load_dwordx4 a[92:95], v0, s[48:51], s8 offen offset:3072 nt
    s_waitcnt vmcnt(20)
    v_dot2_f32_bf16 v28, v112, v4, 0
    v_dot2_f32_bf16 v29, v116, v4, 0
    v_dot2_f32_bf16 v30, v120, v4, 0
    v_dot2_f32_bf16 v31, v124, v4, 0
    v_dot2c_f32_bf16 v28, v113, v5
    v_dot2c_f32_bf16 v29, v117, v5
    v_dot2c_f32_bf16 v30, v121, v5
    v_dot2c_f32_bf16 v31, v125, v5
    v_dot2c_f32_bf16 v28, v114, v6
    v_dot2c_f32_bf16 v29, v118, v6
    v_dot2c_f32_bf16 v30, v122, v6
    v_dot2c_f32_bf16 v31, v126, v6
    v_dot2c_f32_bf16 v28, v115, v7
    v_dot2c_f32_bf16 v29, v119, v7
    v_dot2c_f32_bf16 v30, v123, v7
    v_dot2c_f32_bf16 v31, v127, v7
    v_add_f32_dpp v32, v28, v28 row_ror:8 row_mask:0xf bank_mask:0x3
    s_nop 0
    v_add_f32_dpp v33, v30, v30 row_ror:8 row_mask:0xf bank_mask:0x3
    v_add_f32_dpp v32, v29, v29 row_ror:8 row_mask:0xf bank_mask:0xc
    v_add_f32_dpp v33, v31, v31 row_ror:8 row_mask:0xf bank_mask:0xc
    s_nop 0
    v_add_f32_dpp v34, v32, v32 row_shl:4 row_mask:0xf bank_mask:0x5
    v_add_f32_dpp v34, v33, v33 row_shr:4 row_mask:0xf bank_mask:0xa
    s_nop 1
    v_add_f32_dpp v34, v34, v34 quad_perm:[2,3,0,1] row_mask:0xf bank_mask:0xf
    s_nop 1
    v_add_f32_dpp v34, v34, v34 quad_perm:[1,0,3,2] row_mask:0xf bank_mask:0xf
    v_cvt_pk_bf16_f32 v36, v34, v34
    v_and_b32 v34, 0xffff0000, v36
    v_mul_f32 v34, 0x3db504f3, v34
    v_cvt_pk_bf16_f32 v36, v34, v34
    v_and_b32 v34, 0xffff0000, v36
    s_nop 1
    v_max_f32_dpp v36, v34, v34 row_ror:4 row_mask:0xf bank_mask:0xf
    s_nop 1
    v_max_f32_dpp v36, v36, v36 row_ror:8 row_mask:0xf bank_mask:0xf
    v_mov_b32 v37, v36
    s_nop 1
    v_permlane16_swap_b32 v36, v37
    v_max_f32 v36, v36, v37
    v_mov_b32 v37, v36
    s_nop 1
    v_permlane32_swap_b32 v36, v37
    v_max_f32 v36, v36, v37
    v_max_f32 v36, v36, v24
    v_sub_f32 v37, v34, v36
    v_sub_f32 v38, v24, v36
    v_mul_f32 v37, 0x3fb8aa3b, v37
    v_mul_f32 v38, 0x3fb8aa3b, v38
    v_exp_f32 v37, v37
    v_exp_f32 v26, v38
    v_mov_b32 v24, v36
    v_cvt_pk_bf16_f32 v35, v37, v37
    v_fma_f32 v25, v25, v26, v37
    v_mul_f32 v12, v12, v26
    v_mul_f32 v13, v13, v26
    v_mul_f32 v14, v14, v26
    v_mul_f32 v15, v15, v26
    s_waitcnt vmcnt(16)
    v_and_b32_dpp v16, v35, v8 row_newbcast:0 row_mask:0xf bank_mask:0xf
    v_and_b32_dpp v17, v35, v9 row_newbcast:0 row_mask:0xf bank_mask:0xf
    v_and_b32_dpp v18, v35, v10 row_newbcast:0 row_mask:0xf bank_mask:0xf
    v_and_b32_dpp v19, v35, v11 row_newbcast:0 row_mask:0xf bank_mask:0xf
    v_and_b32_dpp v20, v35, v8 row_newbcast:8 row_mask:0xf bank_mask:0xf
    v_and_b32_dpp v21, v35, v9 row_newbcast:8 row_mask:0xf bank_mask:0xf
    v_and_b32_dpp v22, v35, v10 row_newbcast:8 row_mask:0xf bank_mask:0xf
    v_and_b32_dpp v23, v35, v11 row_newbcast:8 row_mask:0xf bank_mask:0xf
    v_mfma_f32_16x16x32_bf16 v[12:15], v[16:19], a[48:51], v[12:15]
    v_and_b32_dpp v16, v35, v8 row_newbcast:4 row_mask:0xf bank_mask:0xf
    v_and_b32_dpp v17, v35, v9 row_newbcast:4 row_mask:0xf bank_mask:0xf
    v_and_b32_dpp v18, v35, v10 row_newbcast:4 row_mask:0xf bank_mask:0xf
    v_and_b32_dpp v19, v35, v11 row_newbcast:4 row_mask:0xf bank_mask:0xf
    v_mfma_f32_16x16x32_bf16 v[12:15], v[20:23], a[52:55], v[12:15]
    v_and_b32_dpp v20, v35, v8 row_newbcast:12 row_mask:0xf bank_mask:0xf
    v_and_b32_dpp v21, v35, v9 row_newbcast:12 row_mask:0xf bank_mask:0xf
    v_and_b32_dpp v22, v35, v10 row_newbcast:12 row_mask:0xf bank_mask:0xf
    v_and_b32_dpp v23, v35, v11 row_newbcast:12 row_mask:0xf bank_mask:0xf
    v_mfma_f32_16x16x32_bf16 v[12:15], v[16:19], a[56:59], v[12:15]
    s_nop 0
    v_mfma_f32_16x16x32_bf16 v[12:15], v[20:23], a[60:63], v[12:15]
    s_cmp_le_u32 s6, 18
    s_cbranch_scc1 L_tskip_9
    s_mov_b32 s8, s14
    s_waitcnt vmcnt(15)
    buffer_load_dwordx4 v[160:163], v0, s[44:47], s8 offen offset:0 nt
    s_waitcnt vmcnt(15)
    buffer_load_dwordx4 v[164:167], v0, s[44:47], s8 offen offset:1024 nt
    s_waitcnt vmcnt(15)
    buffer_load_dwordx4 v[168:171], v0, s[44:47], s8 offen offset:2048 nt
    s_waitcnt vmcnt(15)
    buffer_load_dwordx4 v[172:175], v0, s[44:47], s8 offen offset:3072 nt
    s_waitcnt vmcnt(15)
    buffer_load_dwordx4 a[96:99], v0, s[48:51], s8 offen offset:0 nt
    s_waitcnt vmcnt(15)
    buffer_load_dwordx4 a[100:103], v0, s[48:51], s8 offen offset:1024 nt
    s_waitcnt vmcnt(15)
    buffer_load_dwordx4 a[104:107], v0, s[48:51], s8 offen offset:2048 nt
    s_waitcnt vmcnt(15)
    buffer_load_dwordx4 a[108:111], v0, s[48:51], s8 offen offset:3072 nt
L_tskip_9:
    s_cmp_lg_u32 s6, 18
    s_cbranch_scc1 L_wn_11
    s_waitcnt vmcnt(12)
    s_branch L_wd_10
L_wn_11:
    s_waitcnt vmcnt(20)
L_wd_10:
    v_dot2_f32_bf16 v28, v128, v4, 0
    v_dot2_f32_bf16 v29, v132, v4, 0
    v_dot2_f32_bf16 v30, v136, v4, 0
    v_dot2_f32_bf16 v31, v140, v4, 0
    v_dot2c_f32_bf16 v28, v129, v5
    v_dot2c_f32_bf16 v29, v133, v5
    v_dot2c_f32_bf16 v30, v137, v5
    v_dot2c_f32_bf16 v31, v141, v5
    v_dot2c_f32_bf16 v28, v130, v6
    v_dot2c_f32_bf16 v29, v134, v6
    v_dot2c_f32_bf16 v30, v138, v6
    v_dot2c_f32_bf16 v31, v142, v6
    v_dot2c_f32_bf16 v28, v131, v7
    v_dot2c_f32_bf16 v29, v135, v7
    v_dot2c_f32_bf16 v30, v139, v7
    v_dot2c_f32_bf16 v31, v143, v7
    v_add_f32_dpp v32, v28, v28 row_ror:8 row_mask:0xf bank_mask:0x3
    s_nop 0
    v_add_f32_dpp v33, v30, v30 row_ror:8 row_mask:0xf bank_mask:0x3
    v_add_f32_dpp v32, v29, v29 row_ror:8 row_mask:0xf bank_mask:0xc
    v_add_f32_dpp v33, v31, v31 row_ror:8 row_mask:0xf bank_mask:0xc
    s_nop 0
    v_add_f32_dpp v34, v32, v32 row_shl:4 row_mask:0xf bank_mask:0x5
    v_add_f32_dpp v34, v33, v33 row_shr:4 row_mask:0xf bank_mask:0xa
    s_nop 1
    v_add_f32_dpp v34, v34, v34 quad_perm:[2,3,0,1] row_mask:0xf bank_mask:0xf
    s_nop 1
    v_add_f32_dpp v34, v34, v34 quad_perm:[1,0,3,2] row_mask:0xf bank_mask:0xf
    v_cvt_pk_bf16_f32 v36, v34, v34
    v_and_b32 v34, 0xffff0000, v36
    v_mul_f32 v34, 0x3db504f3, v34
    v_cvt_pk_bf16_f32 v36, v34, v34
    v_and_b32 v34, 0xffff0000, v36
    s_nop 1
    v_max_f32_dpp v36, v34, v34 row_ror:4 row_mask:0xf bank_mask:0xf
    s_nop 1
    v_max_f32_dpp v36, v36, v36 row_ror:8 row_mask:0xf bank_mask:0xf
    v_mov_b32 v37, v36
    s_nop 1
    v_permlane16_swap_b32 v36, v37
    v_max_f32 v36, v36, v37
    v_mov_b32 v37, v36
    s_nop 1
    v_permlane32_swap_b32 v36, v37
    v_max_f32 v36, v36, v37
    v_max_f32 v36, v36, v24
    v_sub_f32 v37, v34, v36
    v_sub_f32 v38, v24, v36
    v_mul_f32 v37, 0x3fb8aa3b, v37
    v_mul_f32 v38, 0x3fb8aa3b, v38
    v_exp_f32 v37, v37
    v_exp_f32 v26, v38
    v_mov_b32 v24, v36
    v_cvt_pk_bf16_f32 v35, v37, v37
    v_fma_f32 v25, v25, v26, v37
    v_mul_f32 v12, v12, v26
    v_mul_f32 v13, v13, v26
    v_mul_f32 v14, v14, v26
    v_mul_f32 v15, v15, v26
    s_cmp_lg_u32 s6, 18
    s_cbranch_scc1 L_wn_13
    s_waitcnt vmcnt(8)
    s_branch L_wd_12
L_wn_13:
    s_waitcnt vmcnt(16)
L_wd_12:
    v_and_b32_dpp v16, v35, v8 row_newbcast:0 row_mask:0xf bank_mask:0xf
    v_and_b32_dpp v17, v35, v9 row_newbcast:0 row_mask:0xf bank_mask:0xf
    v_and_b32_dpp v18, v35, v10 row_newbcast:0 row_mask:0xf bank_mask:0xf
    v_and_b32_dpp v19, v35, v11 row_newbcast:0 row_mask:0xf bank_mask:0xf
    v_and_b32_dpp v20, v35, v8 row_newbcast:8 row_mask:0xf bank_mask:0xf
    v_and_b32_dpp v21, v35, v9 row_newbcast:8 row_mask:0xf bank_mask:0xf
    v_and_b32_dpp v22, v35, v10 row_newbcast:8 row_mask:0xf bank_mask:0xf
    v_and_b32_dpp v23, v35, v11 row_newbcast:8 row_mask:0xf bank_mask:0xf
    v_mfma_f32_16x16x32_bf16 v[12:15], v[16:19], a[64:67], v[12:15]
    v_and_b32_dpp v16, v35, v8 row_newbcast:4 row_mask:0xf bank_mask:0xf
    v_and_b32_dpp v17, v35, v9 row_newbcast:4 row_mask:0xf bank_mask:0xf
    v_and_b32_dpp v18, v35, v10 row_newbcast:4 row_mask:0xf bank_mask:0xf
    v_and_b32_dpp v19, v35, v11 row_newbcast:4 row_mask:0xf bank_mask:0xf
    v_mfma_f32_16x16x32_bf16 v[12:15], v[20:23], a[68:71], v[12:15]
    v_and_b32_dpp v20, v35, v8 row_newbcast:12 row_mask:0xf bank_mask:0xf
    v_and_b32_dpp v21, v35, v9 row_newbcast:12 row_mask:0xf bank_mask:0xf
    v_and_b32_dpp v22, v35, v10 row_newbcast:12 row_mask:0xf bank_mask:0xf
    v_and_b32_dpp v23, v35, v11 row_newbcast:12 row_mask:0xf bank_mask:0xf
    v_mfma_f32_16x16x32_bf16 v[12:15], v[16:19], a[72:75], v[12:15]
    s_nop 0
    v_mfma_f32_16x16x32_bf16 v[12:15], v[20:23], a[76:79], v[12:15]
    s_cmp_lg_u32 s6, 18
    s_cbranch_scc1 L_wn_15
    s_waitcnt vmcnt(4)
    s_branch L_wd_14
L_wn_15:
    s_waitcnt vmcnt(12)
L_wd_14:
    v_dot2_f32_bf16 v28, v144, v4, 0
    v_dot2_f32_bf16 v29, v148, v4, 0
    v_dot2_f32_bf16 v30, v152, v4, 0
    v_dot2_f32_bf16 v31, v156, v4, 0
    v_dot2c_f32_bf16 v28, v145, v5
    v_dot2c_f32_bf16 v29, v149, v5
    v_dot2c_f32_bf16 v30, v153, v5
    v_dot2c_f32_bf16 v31, v157, v5
    v_dot2c_f32_bf16 v28, v146, v6
    v_dot2c_f32_bf16 v29, v150, v6
    v_dot2c_f32_bf16 v30, v154, v6
    v_dot2c_f32_bf16 v31, v158, v6
    v_dot2c_f32_bf16 v28, v147, v7
    v_dot2c_f32_bf16 v29, v151, v7
    v_dot2c_f32_bf16 v30, v155, v7
    v_dot2c_f32_bf16 v31, v159, v7
    v_add_f32_dpp v32, v28, v28 row_ror:8 row_mask:0xf bank_mask:0x3
    s_nop 0
    v_add_f32_dpp v33, v30, v30 row_ror:8 row_mask:0xf bank_mask:0x3
    v_add_f32_dpp v32, v29, v29 row_ror:8 row_mask:0xf bank_mask:0xc
    v_add_f32_dpp v33, v31, v31 row_ror:8 row_mask:0xf bank_mask:0xc
    s_nop 0
    v_add_f32_dpp v34, v32, v32 row_shl:4 row_mask:0xf bank_mask:0x5
    v_add_f32_dpp v34, v33, v33 row_shr:4 row_mask:0xf bank_mask:0xa
    s_nop 1
    v_add_f32_dpp v34, v34, v34 quad_perm:[2,3,0,1] row_mask:0xf bank_mask:0xf
    s_nop 1
    v_add_f32_dpp v34, v34, v34 quad_perm:[1,0,3,2] row_mask:0xf bank_mask:0xf
    v_cvt_pk_bf16_f32 v36, v34, v34
    v_and_b32 v34, 0xffff0000, v36
    v_mul_f32 v34, 0x3db504f3, v34
    v_cvt_pk_bf16_f32 v36, v34, v34
    v_and_b32 v34, 0xffff0000, v36
    s_nop 1
    v_max_f32_dpp v36, v34, v34 row_ror:4 row_mask:0xf bank_mask:0xf
    s_nop 1
    v_max_f32_dpp v36, v36, v36 row_ror:8 row_mask:0xf bank_mask:0xf
    v_mov_b32 v37, v36
    s_nop 1
    v_permlane16_swap_b32 v36, v37
    v_max_f32 v36, v36, v37
    v_mov_b32 v37, v36
    s_nop 1
    v_permlane32_swap_b32 v36, v37
    v_max_f32 v36, v36, v37
    v_max_f32 v36, v36, v24
    v_sub_f32 v37, v34, v36
    v_sub_f32 v38, v24, v36
    v_mul_f32 v37, 0x3fb8aa3b, v37
    v_mul_f32 v38, 0x3fb8aa3b, v38
    v_exp_f32 v37, v37
    v_exp_f32 v26, v38
    v_mov_b32 v24, v36
    v_cvt_pk_bf16_f32 v35, v37, v37
    v_fma_f32 v25, v25, v26, v37
    v_mul_f32 v12, v12, v26
    v_mul_f32 v13, v13, v26
    v_mul_f32 v14, v14, v26
    v_mul_f32 v15, v15, v26
    s_cmp_eq_u32 s6, 18
    s_cbranch_scc1 L_last_17
    s_waitcnt vmcnt(8)
    v_and_b32_dpp v16, v35, v8 row_newbcast:0 row_mask:0xf bank_mask:0xf
    v_and_b32_dpp v17, v35, v9 row_newbcast:0 row_mask:0xf bank_mask:0xf
    v_and_b32_dpp v18, v35, v10 row_newbcast:0 row_mask:0xf bank_mask:0xf
    v_and_b32_dpp v19, v35, v11 row_newbcast:0 row_mask:0xf bank_mask:0xf
    v_and_b32_dpp v20, v35, v8 row_newbcast:8 row_mask:0xf bank_mask:0xf
    v_and_b32_dpp v21, v35, v9 row_newbcast:8 row_mask:0xf bank_mask:0xf
    v_and_b32_dpp v22, v35, v10 row_newbcast:8 row_mask:0xf bank_mask:0xf
    v_and_b32_dpp v23, v35, v11 row_newbcast:8 row_mask:0xf bank_mask:0xf
    v_mfma_f32_16x16x32_bf16 v[12:15], v[16:19], a[80:83], v[12:15]
    v_and_b32_dpp v16, v35, v8 row_newbcast:4 row_mask:0xf bank_mask:0xf
    v_and_b32_dpp v17, v35, v9 row_newbcast:4 row_mask:0xf bank_mask:0xf
    v_and_b32_dpp v18, v35, v10 row_newbcast:4 row_mask:0xf bank_mask:0xf
    v_and_b32_dpp v19, v35, v11 row_newbcast:4 row_mask:0xf bank_mask:0xf
    v_mfma_f32_16x16x32_bf16 v[12:15], v[20:23], a[84:87], v[12:15]
    v_and_b32_dpp v20, v35, v8 row_newbcast:12 row_mask:0xf bank_mask:0xf
    v_and_b32_dpp v21, v35, v9 row_newbcast:12 row_mask:0xf bank_mask:0xf
    v_and_b32_dpp v22, v35, v10 row_newbcast:12 row_mask:0xf bank_mask:0xf
    v_and_b32_dpp v23, v35, v11 row_newbcast:12 row_mask:0xf bank_mask:0xf
    v_mfma_f32_16x16x32_bf16 v[12:15], v[16:19], a[88:91], v[12:15]
    s_nop 0
    v_mfma_f32_16x16x32_bf16 v[12:15], v[20:23], a[92:95], v[12:15]
    s_waitcnt vmcnt(4)
    v_dot2_f32_bf16 v28, v160, v4, 0
    v_dot2_f32_bf16 v29, v164, v4, 0
    v_dot2_f32_bf16 v30, v168, v4, 0
    v_dot2_f32_bf16 v31, v172, v4, 0
    v_dot2c_f32_bf16 v28, v161, v5
    v_dot2c_f32_bf16 v29, v165, v5
    v_dot2c_f32_bf16 v30, v169, v5
    v_dot2c_f32_bf16 v31, v173, v5
    v_dot2c_f32_bf16 v28, v162, v6
    v_dot2c_f32_bf16 v29, v166, v6
    v_dot2c_f32_bf16 v30, v170, v6
    v_dot2c_f32_bf16 v31, v174, v6
    v_dot2c_f32_bf16 v28, v163, v7
    v_dot2c_f32_bf16 v29, v167, v7
    v_dot2c_f32_bf16 v30, v171, v7
    v_dot2c_f32_bf16 v31, v175, v7
    v_add_f32_dpp v32, v28, v28 row_ror:8 row_mask:0xf bank_mask:0x3
    s_nop 0
    v_add_f32_dpp v33, v30, v30 row_ror:8 row_mask:0xf bank_mask:0x3
    v_add_f32_dpp v32, v29, v29 row_ror:8 row_mask:0xf bank_mask:0xc
    v_add_f32_dpp v33, v31, v31 row_ror:8 row_mask:0xf bank_mask:0xc
    s_nop 0
    v_add_f32_dpp v34, v32, v32 row_shl:4 row_mask:0xf bank_mask:0x5
    v_add_f32_dpp v34, v33, v33 row_shr:4 row_mask:0xf bank_mask:0xa
    s_nop 1
    v_add_f32_dpp v34, v34, v34 quad_perm:[2,3,0,1] row_mask:0xf bank_mask:0xf
    s_nop 1
    v_add_f32_dpp v34, v34, v34 quad_perm:[1,0,3,2] row_mask:0xf bank_mask:0xf
    v_cvt_pk_bf16_f32 v36, v34, v34
    v_and_b32 v34, 0xffff0000, v36
    v_mul_f32 v34, 0x3db504f3, v34
    v_cvt_pk_bf16_f32 v36, v34, v34
    v_and_b32 v34, 0xffff0000, v36
    s_nop 1
    v_max_f32_dpp v36, v34, v34 row_ror:4 row_mask:0xf bank_mask:0xf
    s_nop 1
    v_max_f32_dpp v36, v36, v36 row_ror:8 row_mask:0xf bank_mask:0xf
    v_mov_b32 v37, v36
    s_nop 1
    v_permlane16_swap_b32 v36, v37
    v_max_f32 v36, v36, v37
    v_mov_b32 v37, v36
    s_nop 1
    v_permlane32_swap_b32 v36, v37
    v_max_f32 v36, v36, v37
    v_max_f32 v36, v36, v24
    v_sub_f32 v37, v34, v36
    v_sub_f32 v38, v24, v36
    v_mul_f32 v37, 0x3fb8aa3b, v37
    v_mul_f32 v38, 0x3fb8aa3b, v38
    v_exp_f32 v37, v37
    v_exp_f32 v26, v38
    v_mov_b32 v24, v36
    v_cvt_pk_bf16_f32 v35, v37, v37
    v_fma_f32 v25, v25, v26, v37
    v_mul_f32 v12, v12, v26
    v_mul_f32 v13, v13, v26
    v_mul_f32 v14, v14, v26
    v_mul_f32 v15, v15, v26
    s_branch L_last_18
L_last_17:
    v_add_f32_dpp v36, v25, v25 row_ror:4 row_mask:0xf bank_mask:0xf
    s_nop 1
    v_add_f32_dpp v36, v36, v36 row_ror:8 row_mask:0xf bank_mask:0xf
    v_mov_b32 v37, v36
    s_nop 1
    v_permlane16_swap_b32 v36, v37
    v_add_f32 v36, v36, v37
    v_mov_b32 v37, v36
    s_nop 1
    v_permlane32_swap_b32 v36, v37
    v_add_f32 v36, v36, v37
    v_mov_b32 v32, v24
    v_mov_b32 v33, v36
    s_mov_b64 exec, 1
    buffer_store_dwordx2 v[32:33], v52, s[52:55], s15 offen sc1
    s_mov_b64 exec, -1
    s_waitcnt vmcnt(1)
    v_and_b32_dpp v16, v35, v8 row_newbcast:0 row_mask:0xf bank_mask:0xf
    v_and_b32_dpp v17, v35, v9 row_newbcast:0 row_mask:0xf bank_mask:0xf
    v_and_b32_dpp v18, v35, v10 row_newbcast:0 row_mask:0xf bank_mask:0xf
    v_and_b32_dpp v19, v35, v11 row_newbcast:0 row_mask:0xf bank_mask:0xf
    v_and_b32_dpp v20, v35, v8 row_newbcast:8 row_mask:0xf bank_mask:0xf
    v_and_b32_dpp v21, v35, v9 row_newbcast:8 row_mask:0xf bank_mask:0xf
    v_and_b32_dpp v22, v35, v10 row_newbcast:8 row_mask:0xf bank_mask:0xf
    v_and_b32_dpp v23, v35, v11 row_newbcast:8 row_mask:0xf bank_mask:0xf
    v_mfma_f32_16x16x32_bf16 v[12:15], v[16:19], a[80:83], v[12:15]
    v_and_b32_dpp v16, v35, v8 row_newbcast:4 row_mask:0xf bank_mask:0xf
    v_and_b32_dpp v17, v35, v9 row_newbcast:4 row_mask:0xf bank_mask:0xf
    v_and_b32_dpp v18, v35, v10 row_newbcast:4 row_mask:0xf bank_mask:0xf
    v_and_b32_dpp v19, v35, v11 row_newbcast:4 row_mask:0xf bank_mask:0xf
    v_mfma_f32_16x16x32_bf16 v[12:15], v[20:23], a[84:87], v[12:15]
    v_and_b32_dpp v20, v35, v8 row_newbcast:12 row_mask:0xf bank_mask:0xf
    v_and_b32_dpp v21, v35, v9 row_newbcast:12 row_mask:0xf bank_mask:0xf
    v_and_b32_dpp v22, v35, v10 row_newbcast:12 row_mask:0xf bank_mask:0xf
    v_and_b32_dpp v23, v35, v11 row_newbcast:12 row_mask:0xf bank_mask:0xf
    v_mfma_f32_16x16x32_bf16 v[12:15], v[16:19], a[88:91], v[12:15]
    s_nop 0
    v_mfma_f32_16x16x32_bf16 v[12:15], v[20:23], a[92:95], v[12:15]
    s_mov_b32 exec_hi, 0
    s_nop 6
    buffer_store_dwordx4 v[12:15], v51, s[52:55], s16 offen sc1
    s_endpgm
L_last_18:
    v_add_f32_dpp v36, v25, v25 row_ror:4 row_mask:0xf bank_mask:0xf
    s_nop 1
    v_add_f32_dpp v36, v36, v36 row_ror:8 row_mask:0xf bank_mask:0xf
    v_mov_b32 v37, v36
    s_nop 1
    v_permlane16_swap_b32 v36, v37
    v_add_f32 v36, v36, v37
    v_mov_b32 v37, v36
    s_nop 1
    v_permlane32_swap_b32 v36, v37
    v_add_f32 v36, v36, v37
    v_mov_b32 v32, v24
    v_mov_b32 v33, v36
    s_mov_b64 exec, 1
    buffer_store_dwordx2 v[32:33], v52, s[52:55], s15 offen sc1
    s_mov_b64 exec, -1
    s_waitcnt vmcnt(1)
    v_and_b32_dpp v16, v35, v8 row_newbcast:0 row_mask:0xf bank_mask:0xf
    v_and_b32_dpp v17, v35, v9 row_newbcast:0 row_mask:0xf bank_mask:0xf
    v_and_b32_dpp v18, v35, v10 row_newbcast:0 row_mask:0xf bank_mask:0xf
    v_and_b32_dpp v19, v35, v11 row_newbcast:0 row_mask:0xf bank_mask:0xf
    v_and_b32_dpp v20, v35, v8 row_newbcast:8 row_mask:0xf bank_mask:0xf
    v_and_b32_dpp v21, v35, v9 row_newbcast:8 row_mask:0xf bank_mask:0xf
    v_and_b32_dpp v22, v35, v10 row_newbcast:8 row_mask:0xf bank_mask:0xf
    v_and_b32_dpp v23, v35, v11 row_newbcast:8 row_mask:0xf bank_mask:0xf
    v_mfma_f32_16x16x32_bf16 v[12:15], v[16:19], a[96:99], v[12:15]
    v_and_b32_dpp v16, v35, v8 row_newbcast:4 row_mask:0xf bank_mask:0xf
    v_and_b32_dpp v17, v35, v9 row_newbcast:4 row_mask:0xf bank_mask:0xf
    v_and_b32_dpp v18, v35, v10 row_newbcast:4 row_mask:0xf bank_mask:0xf
    v_and_b32_dpp v19, v35, v11 row_newbcast:4 row_mask:0xf bank_mask:0xf
    v_mfma_f32_16x16x32_bf16 v[12:15], v[20:23], a[100:103], v[12:15]
    v_and_b32_dpp v20, v35, v8 row_newbcast:12 row_mask:0xf bank_mask:0xf
    v_and_b32_dpp v21, v35, v9 row_newbcast:12 row_mask:0xf bank_mask:0xf
    v_and_b32_dpp v22, v35, v10 row_newbcast:12 row_mask:0xf bank_mask:0xf
    v_and_b32_dpp v23, v35, v11 row_newbcast:12 row_mask:0xf bank_mask:0xf
    v_mfma_f32_16x16x32_bf16 v[12:15], v[16:19], a[104:107], v[12:15]
    s_nop 0
    v_mfma_f32_16x16x32_bf16 v[12:15], v[20:23], a[108:111], v[12:15]
    s_mov_b32 exec_hi, 0
    s_nop 6
    buffer_store_dwordx4 v[12:15], v51, s[52:55], s16 offen sc1
    s_endpgm
L_leader:
    s_load_dwordx2 s[44:45], s[0:1], 64
    s_load_dwordx2 s[48:49], s[0:1], 0
    s_load_dwordx2 s[52:53], s[0:1], 96
    s_load_dwordx16 s[16:31], s[0:1], 0
    s_load_dwordx8 s[32:39], s[0:1], 64
    s_cmp_ge_u32 s2, 256
    s_cbranch_scc1 L_exit
    v_lshrrev_b32 v1, 6, v0
    s_lshr_b32 s4, s2, 3
    v_lshlrev_b32 v2, 7, v0
    v_readfirstlane_b32 s3, v1
    v_and_b32 v0, 63, v0
    s_getpc_b64 s[8:9]
L_pf_l:
    v_min_u32 v2, L_exit-L_pf_l, v2
    global_load_dword v152, v2, s[8:9]
    s_mov_b32 s42, 0x40000
    s_mov_b32 s46, 1024
    s_mov_b32 s47, 0x20000
    s_mov_b32 s50, 1024
    s_mov_b32 s51, 0x20000
    s_mov_b32 s54, 268435456
    s_mov_b32 s55, 0x20000
    v_lshrrev_b32 v1, 4, v0
    v_and_b32 v2, 15, v0
    v_bfe_u32 v6, v0, 4, 1
    v_lshlrev_b32 v6, 3, v6
    v_lshl_add_u32 v6, v2, 4, v6
    v_lshrrev_b32 v7, 5, v0
    v_lshl_add_u32 v162, v7, 2, v6
    s_lshl_b32 s6, s3, 8
    v_add_u32 v5, s6, v162
    v_mov_b32 v153, 0
    s_waitcnt lgkmcnt(0)
    buffer_load_dword v54, v5, s[44:47], 0 offen
    buffer_load_dword v55, v5, s[48:51], 0 offen
    buffer_load_dword v4, v153, s[52:55], 0 offen sc1
    v_lshrrev_b32 v6, 3, v2
    v_lshl_add_u32 v6, v1, 1, v6
    v_mul_u32_u24 v6, 98304, v6
    v_and_b32 v7, 7, v2
    v_lshl_add_u32 v169, v7, 4, v6
    s_and_b32 s9, s4, 1
    s_lshl_b32 s9, s9, 2
    s_add_u32 s9, s9, s3
    s_lshl_b32 s15, s9, 7
    v_and_b32 v6, 31, v0
    v_lshlrev_b32 v6, 2, v6
    v_add_u32 v154, s15, v6
    buffer_load_dword v56, v154, s[44:47], 0 offen
    s_mov_b32 s44, s34
    s_mov_b32 s45, s35
    s_mov_b32 s46, 3145728
    s_mov_b32 s47, 0x20000
    v_lshrrev_b32 v155, 1, v169
    v_and_b32 v7, 7, v2
    v_lshrrev_b32 v6, 3, v2
    v_lshl_add_u32 v6, v1, 1, v6
    v_mul_u32_u24 v6, 49152, v6
    v_lshl_add_u32 v155, v7, 4, v6
    s_mul_i32 s8, s9, 393216
    s_lshr_b32 s9, s4, 1
    s_lshl_b32 s9, s9, 7
    s_add_u32 s8, s8, s9
    buffer_load_dwordx4 a[128:131], v155, s[44:47], s8 offen nt
    s_add_u32 s8, s8, 6144
    buffer_load_dwordx4 a[132:135], v155, s[44:47], s8 offen nt
    s_add_u32 s8, s8, 6144
    buffer_load_dwordx4 a[136:139], v155, s[44:47], s8 offen nt
    s_add_u32 s8, s8, 6144
    buffer_load_dwordx4 a[140:143], v155, s[44:47], s8 offen nt
    s_add_u32 s8, s8, 6144
    buffer_load_dwordx4 a[144:147], v155, s[44:47], s8 offen nt
    s_add_u32 s8, s8, 6144
    buffer_load_dwordx4 a[148:151], v155, s[44:47], s8 offen nt
    s_add_u32 s8, s8, 6144
    buffer_load_dwordx4 a[152:155], v155, s[44:47], s8 offen nt
    s_add_u32 s8, s8, 6144
    buffer_load_dwordx4 a[156:159], v155, s[44:47], s8 offen nt
    s_mov_b32 s48, s22
    s_mov_b32 s49, s23
    s_mov_b32 s50, 4194304
    s_mov_b32 s51, 0x20000
    v_lshlrev_b32 v6, 18, v1
    v_lshl_add_u32 v153, v2, 4, v6
    s_mul_i32 s10, s3, 1048576
    s_lshl_b32 s9, s4, 8
    s_add_u32 s10, s10, s9
    buffer_load_dwordx4 a[0:3], v153, s[48:51], s10 offen nt
    s_add_u32 s10, s10, 8192
    buffer_load_dwordx4 a[4:7], v153, s[48:51], s10 offen nt
    s_add_u32 s10, s10, 8192
    buffer_load_dwordx4 a[8:11], v153, s[48:51], s10 offen nt
    s_add_u32 s10, s10, 8192
    buffer_load_dwordx4 a[12:15], v153, s[48:51], s10 offen nt
    s_add_u32 s10, s10, 8192
    buffer_load_dwordx4 a[16:19], v153, s[48:51], s10 offen nt
    s_add_u32 s10, s10, 8192
    buffer_load_dwordx4 a[20:23], v153, s[48:51], s10 offen nt
    s_add_u32 s10, s10, 8192
    buffer_load_dwordx4 a[24:27], v153, s[48:51], s10 offen nt
    s_add_u32 s10, s10, 8192
    buffer_load_dwordx4 a[28:31], v153, s[48:51], s10 offen nt
    s_add_u32 s10, s10, 8192
    v_and_b32 v6, 7, v2
    v_lshrrev_b32 v7, 1, v6
    v_and_b32 v6, 1, v6
    v_mov_b32 v62, 0x0c0c0100
    v_mov_b32 v63, 0x01000c0c
    v_mov_b32 v64, 0x0c0c0302
    v_mov_b32 v65, 0x03020c0c
    v_cmp_eq_u32 vcc, 1, v6
    s_nop 1
    v_cndmask_b32 v62, v62, v63, vcc
    v_cndmask_b32 v64, v64, v65, vcc
    v_mov_b32 v63, 0x0c0c0c0c
    v_cmp_eq_u32 vcc, 0, v7
    s_nop 1
    v_cndmask_b32 v8, v63, v62, vcc
    v_cndmask_b32 v12, v63, v64, vcc
    v_cmp_eq_u32 vcc, 1, v7
    s_nop 1
    v_cndmask_b32 v9, v63, v62, vcc
    v_cndmask_b32 v13, v63, v64, vcc
    v_cmp_eq_u32 vcc, 2, v7
    s_nop 1
    v_cndmask_b32 v10, v63, v62, vcc
    v_cndmask_b32 v14, v63, v64, vcc
    v_cmp_eq_u32 vcc, 3, v7
    s_nop 1
    v_cndmask_b32 v11, v63, v62, vcc
    v_cndmask_b32 v15, v63, v64, vcc
    v_lshrrev_b32 v6, 3, v2
    v_lshl_add_u32 v6, v1, 1, v6
    v_lshlrev_b32 v167, 5, v6
    v_lshlrev_b32 v168, 6, v1
    v_lshrrev_b32 v6, 1, v1
    v_lshlrev_b32 v6, 8, v6
    v_and_b32 v7, 7, v2
    v_lshl_add_u32 v6, v7, 5, v6
    v_and_b32 v7, 1, v1
    v_lshl_add_u32 v6, v7, 4, v6
    s_lshl_b32 s8, s3, 9
    v_add_u32 v157, s8, v6
    s_waitcnt vmcnt(16)
    v_lshlrev_b32 v66, 16, v56
    v_and_b32 v67, 0xffff0000, v56
    v_mul_f32 v6, 0x3fb8aa3b, v66
    v_exp_f32 v6, -v6
    s_nop 0
    v_add_f32 v6, 1.0, v6
    v_rcp_f32 v7, v6
    s_nop 0
    v_mul_f32 v68, v66, v7
    v_fma_f32 v69, -v68, v6, v66
    v_fma_f32 v66, v69, v7, v68
    v_mul_f32 v6, 0x3fb8aa3b, v67
    v_exp_f32 v6, -v6
    s_nop 0
    v_add_f32 v6, 1.0, v6
    v_rcp_f32 v7, v6
    s_nop 0
    v_mul_f32 v68, v67, v7
    v_fma_f32 v69, -v68, v6, v67
    v_fma_f32 v67, v69, v7, v68
    v_cvt_pk_bf16_f32 v66, v66, v67
    s_lshl_b32 s6, s3, 7
    v_and_b32 v6, 31, v0
    v_lshl_add_u32 v154, v6, 2, s6
    ds_write_b32 v154, v66 offset:16384
    v_lshrrev_b32 v155, 1, v167
    v_add_u32 v155, s6, v155
    s_waitcnt lgkmcnt(0)
    ds_read_b128 v[36:39], v155 offset:16384
    v_lshlrev_b32 v66, 16, v54
    v_and_b32 v67, 0xffff0000, v54
    v_mul_f32 v6, 0x3fb8aa3b, v66
    v_exp_f32 v6, -v6
    s_nop 0
    v_add_f32 v6, 1.0, v6
    v_rcp_f32 v7, v6
    s_nop 0
    v_mul_f32 v68, v66, v7
    v_fma_f32 v69, -v68, v6, v66
    v_fma_f32 v66, v69, v7, v68
    v_mul_f32 v6, 0x3fb8aa3b, v67
    v_exp_f32 v6, -v6
    s_nop 0
    v_add_f32 v6, 1.0, v6
    v_rcp_f32 v7, v6
    s_nop 0
    v_mul_f32 v68, v67, v7
    v_fma_f32 v69, -v68, v6, v67
    v_fma_f32 v67, v69, v7, v68
    v_cvt_pk_bf16_f32 v66, v66, v67
    s_lshl_b32 s6, s3, 8
    v_add_u32 v154, s6, v162
    ds_write_b32 v154, v66 offset:0
    v_add_u32 v155, s6, v167
    s_waitcnt lgkmcnt(0)
    ds_read_b128 v[28:31], v155 offset:0
    ds_read_b128 v[32:35], v155 offset:16
    v_lshlrev_b32 v44, 16, v55
    v_and_b32 v45, 0xffff0000, v55
    s_mov_b32 s8, 2654435761
    v_mul_lo_u32 v3, v4, s8
    v_add_u32 v3, 2135587861, v3
    s_waitcnt lgkmcnt(0)
    v_mov_b32 v170, v28
    v_mov_b32 v171, v29
    v_mov_b32 v172, v30
    v_mov_b32 v173, v31
    v_mov_b32 v174, v32
    v_mov_b32 v175, v33
    v_mov_b32 v176, v34
    v_mov_b32 v177, v35
    v_perm_b32 v16, v36, v36, v8
    v_perm_b32 v17, v36, v36, v9
    v_perm_b32 v18, v36, v36, v10
    v_perm_b32 v19, v36, v36, v11
    v_perm_b32 v20, v36, v36, v12
    v_perm_b32 v21, v36, v36, v13
    v_perm_b32 v22, v36, v36, v14
    v_perm_b32 v23, v36, v36, v15
    s_waitcnt vmcnt(15)
    v_mfma_f32_16x16x32_bf16 v[24:27], v[16:19], a[128:131], 0
    v_perm_b32 v16, v37, v37, v8
    v_perm_b32 v17, v37, v37, v9
    v_perm_b32 v18, v37, v37, v10
    v_perm_b32 v19, v37, v37, v11
    s_waitcnt vmcnt(14)
    v_mfma_f32_16x16x32_bf16 v[24:27], v[20:23], a[132:135], v[24:27]
    v_perm_b32 v20, v37, v37, v12
    v_perm_b32 v21, v37, v37, v13
    v_perm_b32 v22, v37, v37, v14
    v_perm_b32 v23, v37, v37, v15
    s_waitcnt vmcnt(13)
    v_mfma_f32_16x16x32_bf16 v[24:27], v[16:19], a[136:139], v[24:27]
    v_perm_b32 v16, v38, v38, v8
    v_perm_b32 v17, v38, v38, v9
    v_perm_b32 v18, v38, v38, v10
    v_perm_b32 v19, v38, v38, v11
    s_waitcnt vmcnt(12)
    v_mfma_f32_16x16x32_bf16 v[24:27], v[20:23], a[140:143], v[24:27]
    v_perm_b32 v20, v38, v38, v12
    v_perm_b32 v21, v38, v38, v13
    v_perm_b32 v22, v38, v38, v14
    v_perm_b32 v23, v38, v38, v15
    s_waitcnt vmcnt(11)
    v_mfma_f32_16x16x32_bf16 v[24:27], v[16:19], a[144:147], v[24:27]
    v_perm_b32 v16, v39, v39, v8
    v_perm_b32 v17, v39, v39, v9
    v_perm_b32 v18, v39, v39, v10
    v_perm_b32 v19, v39, v39, v11
    s_waitcnt vmcnt(10)
    v_mfma_f32_16x16x32_bf16 v[24:27], v[20:23], a[148:151], v[24:27]
    v_perm_b32 v20, v39, v39, v12
    v_perm_b32 v21, v39, v39, v13
    v_perm_b32 v22, v39, v39, v14
    v_perm_b32 v23, v39, v39, v15
    s_waitcnt vmcnt(9)
    v_mfma_f32_16x16x32_bf16 v[24:27], v[16:19], a[152:155], v[24:27]
    s_waitcnt vmcnt(8)
    v_mfma_f32_16x16x32_bf16 v[24:27], v[20:23], a[156:159], v[24:27]
    s_mov_b32 exec_lo, 0x00ff00ff
    s_mov_b32 exec_hi, 0xff00ff00
    s_nop 5
    ds_write_b128 v157, v[24:27] offset:4096
    s_mov_b64 exec, -1
    s_waitcnt lgkmcnt(0)
    s_barrier
    s_cmp_lg_u32 s3, 0
    s_cbranch_scc1 L_w0_16
    v_and_b32 v6, 31, v0
    v_lshlrev_b32 v6, 3, v6
    ds_read_b64 v[66:67], v6 offset:4096
    ds_read_b64 v[68:69], v6 offset:4352
    ds_read_b64 v[70:71], v6 offset:4608
    ds_read_b64 v[72:73], v6 offset:4864
    ds_read_b64 v[74:75], v6 offset:5120
    ds_read_b64 v[76:77], v6 offset:5376
    ds_read_b64 v[78:79], v6 offset:5632
    ds_read_b64 v[80:81], v6 offset:5888
    s_waitcnt lgkmcnt(0)
    v_pk_add_f32 v[66:67], v[66:67], v[74:75]
    v_pk_add_f32 v[68:69], v[68:69], v[76:77]
    v_pk_add_f32 v[70:71], v[70:71], v[78:79]
    v_pk_add_f32 v[72:73], v[72:73], v[80:81]
    v_pk_add_f32 v[66:67], v[66:67], v[70:71]
    v_pk_add_f32 v[68:69], v[68:69], v[72:73]
    v_pk_add_f32 v[66:67], v[66:67], v[68:69]
    v_mov_b32 v54, v66
    v_mov_b32 v55, v3
    v_mov_b32 v56, v67
    v_mov_b32 v57, v3
    s_lshl_b32 s8, s4, 9
    s_add_u32 s8, s8, 40960
    v_lshlrev_b32 v154, 4, v0
    s_mov_b32 exec_hi, 0
    buffer_store_dwordx4 v[54:57], v154, s[52:55], s8 offen sc1
    s_mov_b64 exec, -1
L_w0_16:
    buffer_load_dwordx4 a[32:35], v153, s[48:51], s10 offen nt
    s_add_u32 s10, s10, 8192
    buffer_load_dwordx4 a[36:39], v153, s[48:51], s10 offen nt
    s_add_u32 s10, s10, 8192
    buffer_load_dwordx4 a[40:43], v153, s[48:51], s10 offen nt
    s_add_u32 s10, s10, 8192
    buffer_load_dwordx4 a[44:47], v153, s[48:51], s10 offen nt
    s_add_u32 s10, s10, 8192
    buffer_load_dwordx4 a[48:51], v153, s[48:51], s10 offen nt
    s_add_u32 s10, s10, 8192
    buffer_load_dwordx4 a[52:55], v153, s[48:51], s10 offen nt
    s_add_u32 s10, s10, 8192
    buffer_load_dwordx4 a[56:59], v153, s[48:51], s10 offen nt
    s_add_u32 s10, s10, 8192
    buffer_load_dwordx4 a[60:63], v153, s[48:51], s10 offen nt
    s_add_u32 s10, s10, 8192
    buffer_load_dwordx4 a[64:67], v153, s[48:51], s10 offen nt
    s_add_u32 s10, s10, 8192
    buffer_load_dwordx4 a[68:71], v153, s[48:51], s10 offen nt
    s_add_u32 s10, s10, 8192
    buffer_load_dwordx4 a[72:75], v153, s[48:51], s10 offen nt
    s_add_u32 s10, s10, 8192
    buffer_load_dwordx4 a[76:79], v153, s[48:51], s10 offen nt
    s_add_u32 s10, s10, 8192
    buffer_load_dwordx4 a[80:83], v153, s[48:51], s10 offen nt
    s_add_u32 s10, s10, 8192
    buffer_load_dwordx4 a[84:87], v153, s[48:51], s10 offen nt
    s_add_u32 s10, s10, 8192
    buffer_load_dwordx4 a[88:91], v153, s[48:51], s10 offen nt
    s_add_u32 s10, s10, 8192
    buffer_load_dwordx4 a[92:95], v153, s[48:51], s10 offen nt
    s_add_u32 s10, s10, 8192
    buffer_load_dwordx4 a[96:99], v153, s[48:51], s10 offen nt
    s_add_u32 s10, s10, 8192
    buffer_load_dwordx4 a[100:103], v153, s[48:51], s10 offen nt
    s_add_u32 s10, s10, 8192
    buffer_load_dwordx4 a[104:107], v153, s[48:51], s10 offen nt
    s_add_u32 s10, s10, 8192
    buffer_load_dwordx4 a[108:111], v153, s[48:51], s10 offen nt
    s_add_u32 s10, s10, 8192
    buffer_load_dwordx4 a[112:115], v153, s[48:51], s10 offen nt
    s_add_u32 s10, s10, 8192
    buffer_load_dwordx4 a[116:119], v153, s[48:51], s10 offen nt
    s_add_u32 s10, s10, 8192
    buffer_load_dwordx4 a[120:123], v153, s[48:51], s10 offen nt
    s_add_u32 s10, s10, 8192
    buffer_load_dwordx4 a[124:127], v153, s[48:51], s10 offen nt
    s_lshl_b32 s14, s4, 15
    s_add_u32 s14, s14, 65536
    v_mov_b32 v58, -1
    v_mov_b32 v59, -1
    v_mov_b32 v60, -1
    v_mov_b32 v61, -1
    v_lshlrev_b32 v154, 4, v0
    s_lshl_b32 s8, s3, 10
    s_add_u32 s8, s8, s14
    buffer_store_dwordx4 v[58:61], v154, s[52:55], s8 offen sc1
    s_add_u32 s8, s8, 4096
    buffer_store_dwordx4 v[58:61], v154, s[52:55], s8 offen sc1
    s_add_u32 s8, s8, 4096
    buffer_store_dwordx4 v[58:61], v154, s[52:55], s8 offen sc1
    s_add_u32 s8, s8, 4096
    buffer_store_dwordx4 v[58:61], v154, s[52:55], s8 offen sc1
    s_add_u32 s8, s8, 4096
    buffer_store_dwordx4 v[58:61], v154, s[52:55], s8 offen sc1
    v_readfirstlane_b32 s8, v44
    s_nop 1
    v_subrev_f32 v70, s8, v44
    v_subrev_f32 v71, s8, v45
    v_add_f32 v66, v70, v71
    v_mul_f32 v67, v70, v70
    v_fmac_f32 v67, v71, v71
    v_mov_b32 v68, s8
    v_add_f32_dpp v66, v66, v66 quad_perm:[1,0,3,2] row_mask:0xf bank_mask:0xf
    v_add_f32_dpp v67, v67, v67 quad_perm:[1,0,3,2] row_mask:0xf bank_mask:0xf
    s_nop 0
    v_add_f32_dpp v66, v66, v66 quad_perm:[2,3,0,1] row_mask:0xf bank_mask:0xf
    v_add_f32_dpp v67, v67, v67 quad_perm:[2,3,0,1] row_mask:0xf bank_mask:0xf
    s_nop 0
    v_add_f32_dpp v66, v66, v66 row_ror:4 row_mask:0xf bank_mask:0xf
    v_add_f32_dpp v67, v67, v67 row_ror:4 row_mask:0xf bank_mask:0xf
    s_nop 0
    v_add_f32_dpp v66, v66, v66 row_ror:8 row_mask:0xf bank_mask:0xf
    v_add_f32_dpp v67, v67, v67 row_ror:8 row_mask:0xf bank_mask:0xf
    v_mov_b32 v6, v66
    v_mov_b32 v7, v67
    s_nop 0
    v_permlane16_swap_b32 v66, v6
    v_permlane16_swap_b32 v67, v7
    v_add_f32 v66, v66, v6
    v_add_f32 v67, v67, v7
    v_mov_b32 v6, v66
    v_mov_b32 v7, v67
    s_nop 0
    v_permlane32_swap_b32 v66, v6
    v_permlane32_swap_b32 v67, v7
    v_add_f32 v66, v66, v6
    v_add_f32 v67, v67, v7
    s_lshl_b32 s8, s3, 4
    v_mov_b32 v6, s8
    ds_write_b128 v6, v[66:69] offset:3840
    v_and_b32 v7, 3, v0
    v_lshlrev_b32 v7, 4, v7
    s_waitcnt lgkmcnt(0)
    s_barrier
    ds_read_b128 v[70:73], v7 offset:3840
    s_nop 0
    s_waitcnt lgkmcnt(0)
    v_mul_f32 v66, 0x3c000000, v70
    v_add_f32 v67, v66, v72
    v_fma_f32 v68, -v66, v70, v71
    s_nop 0
    v_add_f32_dpp v70, v67, v67 quad_perm:[1,0,3,2] row_mask:0xf bank_mask:0xf
    s_nop 1
    v_add_f32_dpp v70, v70, v70 quad_perm:[2,3,0,1] row_mask:0xf bank_mask:0xf
    v_mul_f32 v70, 0x3e800000, v70
    v_sub_f32 v67, v67, v70
    v_mul_f32 v66, 0x43000000, v67
    v_fma_f32 v68, v66, v67, v68
    s_nop 1
    v_add_f32_dpp v71, v68, v68 quad_perm:[1,0,3,2] row_mask:0xf bank_mask:0xf
    s_nop 1
    v_add_f32_dpp v71, v71, v71 quad_perm:[2,3,0,1] row_mask:0xf bank_mask:0xf
    v_mul_f32 v71, 0x3b000000, v71
    v_max_f32 v71, 0, v71
    v_cvt_pk_bf16_f32 v6, v70, v71
    v_lshlrev_b32 v70, 16, v6
    v_and_b32 v71, 0xffff0000, v6
    v_add_f32 v71, 0x3727c5ac, v71
    v_cvt_pk_bf16_f32 v6, v71, v71
    v_and_b32 v71, 0xffff0000, v6
    v_sqrt_f32 v71, v71
    s_nop 0
    v_cvt_pk_bf16_f32 v6, v71, v71
    v_and_b32 v71, 0xffff0000, v6
    v_rcp_f32 v72, v71
    v_sub_f32 v76, v44, v70
    v_sub_f32 v77, v45, v70
    v_cvt_pk_bf16_f32 v6, v76, v77
    v_lshlrev_b32 v76, 16, v6
    v_and_b32 v77, 0xffff0000, v6
    v_mul_f32 v73, v76, v72
    v_mul_f32 v74, v77, v72
    v_fma_f32 v76, -v73, v71, v76
    v_fma_f32 v77, -v74, v71, v77
    v_fma_f32 v76, v76, v72, v73
    v_fma_f32 v77, v77, v72, v74
    v_cvt_pk_bf16_f32 v6, v76, v77
    v_lshlrev_b32 v76, 16, v6
    v_and_b32 v77, 0xffff0000, v6
    v_lshrrev_b32 v6, 7, v5
    v_lshlrev_b32 v6, 10, v6
    v_and_b32 v7, 127, v5
    v_lshl_add_u32 v154, v7, 2, v6
    s_mov_b32 s43, 0
L_poll_sc:
    s_mov_b32 s8, 40960
    buffer_load_dwordx4 v[80:83], v154, s[52:55], s8 offen sc1
    s_mov_b32 s8, 41472
    buffer_load_dwordx4 v[84:87], v154, s[52:55], s8 offen sc1
    s_mov_b32 s8, 49152
    buffer_load_dwordx4 v[88:91], v154, s[52:55], s8 offen sc1
    s_mov_b32 s8, 49664
    buffer_load_dwordx4 v[92:95], v154, s[52:55], s8 offen sc1
    s_waitcnt vmcnt(0)
    v_xor_b32 v6, v81, v3
    v_xor_b32 v7, v83, v3
    v_or_b32 v6, v6, v7
    v_xor_b32 v7, v85, v3
    v_or_b32 v6, v6, v7
    v_xor_b32 v7, v87, v3
    v_or_b32 v6, v6, v7
    v_xor_b32 v7, v89, v3
    v_or_b32 v6, v6, v7
    v_xor_b32 v7, v91, v3
    v_or_b32 v6, v6, v7
    v_xor_b32 v7, v93, v3
    v_or_b32 v6, v6, v7
    v_xor_b32 v7, v95, v3
    v_or_b32 v6, v6, v7
    v_cmp_ne_u32 vcc, 0, v6
    s_cbranch_vccz L_poll_sc_ok
    s_add_u32 s43, s43, 1
    s_cmp_le_u32 s43, s42
    s_nop 1
    s_cbranch_scc1 L_poll_sc
L_poll_sc_ok:
    s_mov_b32 s44, s34
    s_mov_b32 s45, s35
    s_mov_b32 s46, 3145728
    s_mov_b32 s47, 0x20000
    s_and_b32 s8, s4, 7
    s_add_u32 s15, s4, 16
    s_cmp_eq_u32 s8, 3
    s_cselect_b32 s9, 2, 0
    s_sub_u32 s15, s15, s9
    s_cmp_eq_u32 s8, 1
    s_cselect_b32 s9, 2, 0
    s_add_u32 s15, s15, s9
    s_lshr_b32 s11, s4, 2
    s_mul_i32 s11, s11, 3
    s_and_b32 s8, s4, 3
    s_cmp_ge_u32 s8, 2
    s_cselect_b32 s9, 1, 0
    s_sub_u32 s9, s8, s9
    s_add_u32 s11, s11, s9
    s_cmp_gt_u32 s11, 17
    s_cselect_b32 s9, 1, 0
    s_sub_u32 s11, s11, s9
    s_cmp_eq_u32 s8, 1
    s_cselect_b32 s11, 31, s11
    s_cmp_eq_u32 s4, 23
    s_cselect_b32 s11, 31, s11
    s_lshl_b32 s9, s15, 7
    s_mul_i32 s12, s3, 786432
    s_add_u32 s12, s12, s9
    v_add_f32 v66, v80, v84
    v_add_f32 v67, v82, v86
    v_add_f32 v68, v88, v92
    v_add_f32 v69, v90, v94
    v_cvt_pk_bf16_f32 v6, v66, v67
    v_lshlrev_b32 v66, 16, v6
    v_and_b32 v67, 0xffff0000, v6
    v_cvt_pk_bf16_f32 v6, v68, v69
    v_lshlrev_b32 v68, 16, v6
    v_and_b32 v69, 0xffff0000, v6
    v_add_f32 v68, 1.0, v68
    v_add_f32 v69, 1.0, v69
    v_cvt_pk_bf16_f32 v6, v68, v69
    v_lshlrev_b32 v68, 16, v6
    v_and_b32 v69, 0xffff0000, v6
    v_mul_f32 v76, v76, v68
    v_mul_f32 v77, v77, v69
    v_cvt_pk_bf16_f32 v6, v76, v77
    v_lshlrev_b32 v76, 16, v6
    v_and_b32 v77, 0xffff0000, v6
    v_add_f32 v76, v76, v66
    v_add_f32 v77, v77, v67
    v_cvt_pk_bf16_f32 v70, v76, v77
    s_lshl_b32 s6, s3, 8
    v_add_u32 v154, s6, v162
    ds_write_b32 v154, v70 offset:1024
    v_add_u32 v155, s6, v168
    s_waitcnt lgkmcnt(0)
    ds_read_b128 v[28:31], v155 offset:1024
    ds_read_b128 v[32:35], v155 offset:1040
    ds_read_b128 v[36:39], v155 offset:1056
    ds_read_b128 v[40:43], v155 offset:1072
    s_waitcnt lgkmcnt(0)
    v_perm_b32 v16, v28, v28, v8
    v_perm_b32 v17, v28, v28, v9
    v_perm_b32 v18, v28, v28, v10
    v_perm_b32 v19, v28, v28, v11
    v_perm_b32 v20, v28, v28, v12
    v_perm_b32 v21, v28, v28, v13
    v_perm_b32 v22, v28, v28, v14
    v_perm_b32 v23, v28, v28, v15
    v_mfma_f32_16x16x32_bf16 v[24:27], v[16:19], a[0:3], 0
    v_perm_b32 v16, v29, v29, v8
    v_perm_b32 v17, v29, v29, v9
    v_perm_b32 v18, v29, v29, v10
    v_perm_b32 v19, v29, v29, v11
    v_mfma_f32_16x16x32_bf16 v[24:27], v[20:23], a[4:7], v[24:27]
    v_perm_b32 v20, v29, v29, v12
    v_perm_b32 v21, v29, v29, v13
    v_perm_b32 v22, v29, v29, v14
    v_perm_b32 v23, v29, v29, v15
    v_mfma_f32_16x16x32_bf16 v[24:27], v[16:19], a[8:11], v[24:27]
    v_perm_b32 v16, v30, v30, v8
    v_perm_b32 v17, v30, v30, v9
    v_perm_b32 v18, v30, v30, v10
    v_perm_b32 v19, v30, v30, v11
    v_mfma_f32_16x16x32_bf16 v[24:27], v[20:23], a[12:15], v[24:27]
    v_perm_b32 v20, v30, v30, v12
    v_perm_b32 v21, v30, v30, v13
    v_perm_b32 v22, v30, v30, v14
    v_perm_b32 v23, v30, v30, v15
    v_mfma_f32_16x16x32_bf16 v[24:27], v[16:19], a[16:19], v[24:27]
    v_perm_b32 v16, v31, v31, v8
    v_perm_b32 v17, v31, v31, v9
    v_perm_b32 v18, v31, v31, v10
    v_perm_b32 v19, v31, v31, v11
    v_mfma_f32_16x16x32_bf16 v[24:27], v[20:23], a[20:23], v[24:27]
    v_perm_b32 v20, v31, v31, v12
    v_perm_b32 v21, v31, v31, v13
    v_perm_b32 v22, v31, v31, v14
    v_perm_b32 v23, v31, v31, v15
    v_mfma_f32_16x16x32_bf16 v[24:27], v[16:19], a[24:27], v[24:27]
    v_perm_b32 v16, v32, v32, v8
    v_perm_b32 v17, v32, v32, v9
    v_perm_b32 v18, v32, v32, v10
    v_perm_b32 v19, v32, v32, v11
    v_mfma_f32_16x16x32_bf16 v[24:27], v[20:23], a[28:31], v[24:27]
    v_perm_b32 v20, v32, v32, v12
    v_perm_b32 v21, v32, v32, v13
    v_perm_b32 v22, v32, v32, v14
    v_perm_b32 v23, v32, v32, v15
    v_mfma_f32_16x16x32_bf16 v[24:27], v[16:19], a[32:35], v[24:27]
    v_perm_b32 v16, v33, v33, v8
    v_perm_b32 v17, v33, v33, v9
    v_perm_b32 v18, v33, v33, v10
    v_perm_b32 v19, v33, v33, v11
    v_mfma_f32_16x16x32_bf16 v[24:27], v[20:23], a[36:39], v[24:27]
    v_perm_b32 v20, v33, v33, v12
    v_perm_b32 v21, v33, v33, v13
    v_perm_b32 v22, v33, v33, v14
    v_perm_b32 v23, v33, v33, v15
    v_mfma_f32_16x16x32_bf16 v[24:27], v[16:19], a[40:43], v[24:27]
    v_perm_b32 v16, v34, v34, v8
    v_perm_b32 v17, v34, v34, v9
    v_perm_b32 v18, v34, v34, v10
    v_perm_b32 v19, v34, v34, v11
    v_mfma_f32_16x16x32_bf16 v[24:27], v[20:23], a[44:47], v[24:27]
    v_perm_b32 v20, v34, v34, v12
    v_perm_b32 v21, v34, v34, v13
    v_perm_b32 v22, v34, v34, v14
    v_perm_b32 v23, v34, v34, v15
    v_mfma_f32_16x16x32_bf16 v[24:27], v[16:19], a[48:51], v[24:27]
    v_perm_b32 v16, v35, v35, v8
    v_perm_b32 v17, v35, v35, v9
    v_perm_b32 v18, v35, v35, v10
    v_perm_b32 v19, v35, v35, v11
    v_mfma_f32_16x16x32_bf16 v[24:27], v[20:23], a[52:55], v[24:27]
    v_perm_b32 v20, v35, v35, v12
    v_perm_b32 v21, v35, v35, v13
    v_perm_b32 v22, v35, v35, v14
    v_perm_b32 v23, v35, v35, v15
    v_mfma_f32_16x16x32_bf16 v[24:27], v[16:19], a[56:59], v[24:27]
    v_perm_b32 v16, v36, v36, v8
    v_perm_b32 v17, v36, v36, v9
    v_perm_b32 v18, v36, v36, v10
    v_perm_b32 v19, v36, v36, v11
    v_mfma_f32_16x16x32_bf16 v[24:27], v[20:23], a[60:63], v[24:27]
    v_perm_b32 v20, v36, v36, v12
    v_perm_b32 v21, v36, v36, v13
    v_perm_b32 v22, v36, v36, v14
    v_perm_b32 v23, v36, v36, v15
    v_mfma_f32_16x16x32_bf16 v[24:27], v[16:19], a[64:67], v[24:27]
    v_perm_b32 v16, v37, v37, v8
    v_perm_b32 v17, v37, v37, v9
    v_perm_b32 v18, v37, v37, v10
    v_perm_b32 v19, v37, v37, v11
    v_mfma_f32_16x16x32_bf16 v[24:27], v[20:23], a[68:71], v[24:27]
    v_perm_b32 v20, v37, v37, v12
    v_perm_b32 v21, v37, v37, v13
    v_perm_b32 v22, v37, v37, v14
    v_perm_b32 v23, v37, v37, v15
    v_mfma_f32_16x16x32_bf16 v[24:27], v[16:19], a[72:75], v[24:27]
    v_perm_b32 v16, v38, v38, v8
    v_perm_b32 v17, v38, v38, v9
    v_perm_b32 v18, v38, v38, v10
    v_perm_b32 v19, v38, v38, v11
    v_mfma_f32_16x16x32_bf16 v[24:27], v[20:23], a[76:79], v[24:27]
    v_perm_b32 v20, v38, v38, v12
    v_perm_b32 v21, v38, v38, v13
    v_perm_b32 v22, v38, v38, v14
    v_perm_b32 v23, v38, v38, v15
    v_mfma_f32_16x16x32_bf16 v[24:27], v[16:19], a[80:83], v[24:27]
    v_perm_b32 v16, v39, v39, v8
    v_perm_b32 v17, v39, v39, v9
    v_perm_b32 v18, v39, v39, v10
    v_perm_b32 v19, v39, v39, v11
    v_mfma_f32_16x16x32_bf16 v[24:27], v[20:23], a[84:87], v[24:27]
    v_perm_b32 v20, v39, v39, v12
    v_perm_b32 v21, v39, v39, v13
    v_perm_b32 v22, v39, v39, v14
    v_perm_b32 v23, v39, v39, v15
    v_mfma_f32_16x16x32_bf16 v[24:27], v[16:19], a[88:91], v[24:27]
    v_perm_b32 v16, v40, v40, v8
    v_perm_b32 v17, v40, v40, v9
    v_perm_b32 v18, v40, v40, v10
    v_perm_b32 v19, v40, v40, v11
    v_mfma_f32_16x16x32_bf16 v[24:27], v[20:23], a[92:95], v[24:27]
    v_perm_b32 v20, v40, v40, v12
    v_perm_b32 v21, v40, v40, v13
    v_perm_b32 v22, v40, v40, v14
    v_perm_b32 v23, v40, v40, v15
    v_mfma_f32_16x16x32_bf16 v[24:27], v[16:19], a[96:99], v[24:27]
    v_perm_b32 v16, v41, v41, v8
    v_perm_b32 v17, v41, v41, v9
    v_perm_b32 v18, v41, v41, v10
    v_perm_b32 v19, v41, v41, v11
    v_mfma_f32_16x16x32_bf16 v[24:27], v[20:23], a[100:103], v[24:27]
    v_perm_b32 v20, v41, v41, v12
    v_perm_b32 v21, v41, v41, v13
    v_perm_b32 v22, v41, v41, v14
    v_perm_b32 v23, v41, v41, v15
    v_mfma_f32_16x16x32_bf16 v[24:27], v[16:19], a[104:107], v[24:27]
    v_perm_b32 v16, v42, v42, v8
    v_perm_b32 v17, v42, v42, v9
    v_perm_b32 v18, v42, v42, v10
    v_perm_b32 v19, v42, v42, v11
    v_mfma_f32_16x16x32_bf16 v[24:27], v[20:23], a[108:111], v[24:27]
    v_perm_b32 v20, v42, v42, v12
    v_perm_b32 v21, v42, v42, v13
    v_perm_b32 v22, v42, v42, v14
    v_perm_b32 v23, v42, v42, v15
    v_mfma_f32_16x16x32_bf16 v[24:27], v[16:19], a[112:115], v[24:27]
    v_perm_b32 v16, v43, v43, v8
    v_perm_b32 v17, v43, v43, v9
    v_perm_b32 v18, v43, v43, v10
    v_perm_b32 v19, v43, v43, v11
    v_mfma_f32_16x16x32_bf16 v[24:27], v[20:23], a[116:119], v[24:27]
    v_perm_b32 v20, v43, v43, v12
    v_perm_b32 v21, v43, v43, v13
    v_perm_b32 v22, v43, v43, v14
    v_perm_b32 v23, v43, v43, v15
    v_mfma_f32_16x16x32_bf16 v[24:27], v[16:19], a[120:123], v[24:27]
    s_nop 0
    v_mfma_f32_16x16x32_bf16 v[24:27], v[20:23], a[124:127], v[24:27]
    v_lshlrev_b32 v6, 5, v2
    v_lshl_add_u32 v6, v1, 4, v6
    s_lshl_b32 s8, s3, 9
    v_add_u32 v154, s8, v6
    s_mov_b32 exec_hi, 0
    s_nop 2
    ds_write_b128 v154, v[24:27] offset:6144
    s_mov_b64 exec, -1
    s_waitcnt lgkmcnt(0)
    s_barrier
    s_cmp_lg_u32 s3, 0
    s_cbranch_scc1 L_w0_17
    v_lshlrev_b32 v6, 3, v0
    ds_read_b64 v[66:67], v6 offset:6144
    ds_read_b64 v[68:69], v6 offset:6656
    ds_read_b64 v[70:71], v6 offset:7168
    ds_read_b64 v[72:73], v6 offset:7680
    s_waitcnt lgkmcnt(0)
    v_pk_add_f32 v[66:67], v[66:67], v[68:69]
    v_pk_add_f32 v[70:71], v[70:71], v[72:73]
    v_pk_add_f32 v[66:67], v[66:67], v[70:71]
    v_cvt_pk_bf16_f32 v54, v66, v67
    v_mov_b32 v55, v3
    s_lshl_b32 s8, s4, 9
    s_add_u32 s8, s8, 20480
    buffer_store_dwordx2 v[54:55], v6, s[52:55], s8 offen sc1
L_w0_17:
    buffer_load_dwordx4 a[128:131], v169, s[44:47], s12 offen nt
    s_add_u32 s12, s12, 6144
    buffer_load_dwordx4 a[132:135], v169, s[44:47], s12 offen nt
    s_add_u32 s12, s12, 6144
    buffer_load_dwordx4 a[136:139], v169, s[44:47], s12 offen nt
    s_add_u32 s12, s12, 6144
    buffer_load_dwordx4 a[140:143], v169, s[44:47], s12 offen nt
    s_add_u32 s12, s12, 6144
    buffer_load_dwordx4 a[144:147], v169, s[44:47], s12 offen nt
    s_add_u32 s12, s12, 6144
    buffer_load_dwordx4 a[148:151], v169, s[44:47], s12 offen nt
    s_add_u32 s12, s12, 6144
    buffer_load_dwordx4 a[152:155], v169, s[44:47], s12 offen nt
    s_add_u32 s12, s12, 6144
    buffer_load_dwordx4 a[156:159], v169, s[44:47], s12 offen nt
    s_add_u32 s12, s12, 6144
    buffer_load_dwordx4 a[160:163], v169, s[44:47], s12 offen nt
    s_add_u32 s12, s12, 6144
    buffer_load_dwordx4 a[164:167], v169, s[44:47], s12 offen nt
    s_add_u32 s12, s12, 6144
    buffer_load_dwordx4 a[168:171], v169, s[44:47], s12 offen nt
    s_add_u32 s12, s12, 6144
    buffer_load_dwordx4 a[172:175], v169, s[44:47], s12 offen nt
    s_add_u32 s12, s12, 6144
    buffer_load_dwordx4 a[176:179], v169, s[44:47], s12 offen nt
    s_add_u32 s12, s12, 6144
    buffer_load_dwordx4 a[180:183], v169, s[44:47], s12 offen nt
    s_add_u32 s12, s12, 6144
    buffer_load_dwordx4 a[184:187], v169, s[44:47], s12 offen nt
    s_add_u32 s12, s12, 6144
    buffer_load_dwordx4 a[188:191], v169, s[44:47], s12 offen nt
    s_mov_b32 s48, s24
    s_mov_b32 s49, s25
    s_mov_b32 s50, 4194304
    s_mov_b32 s51, 0x20000
    v_lshlrev_b32 v6, 15, v1
    v_lshl_add_u32 v153, v2, 4, v6
    s_lshl_b32 s10, s4, 17
    s_lshl_b32 s9, s3, 8
    s_add_u32 s10, s10, s9
    buffer_load_dwordx4 a[0:3], v153, s[48:51], s10 offen offset:0 nt
    buffer_load_dwordx4 a[4:7], v153, s[48:51], s10 offen offset:1024 nt
    buffer_load_dwordx4 a[8:11], v153, s[48:51], s10 offen offset:2048 nt
    buffer_load_dwordx4 a[12:15], v153, s[48:51], s10 offen offset:3072 nt
    s_add_u32 s10, s10, 4096
    buffer_load_dwordx4 a[16:19], v153, s[48:51], s10 offen offset:0 nt
    buffer_load_dwordx4 a[20:23], v153, s[48:51], s10 offen offset:1024 nt
    buffer_load_dwordx4 a[24:27], v153, s[48:51], s10 offen offset:2048 nt
    buffer_load_dwordx4 a[28:31], v153, s[48:51], s10 offen offset:3072 nt
    s_add_u32 s10, s10, 4096
    v_lshrrev_b32 v6, 3, v0
    v_and_b32 v7, 7, v0
    v_lshlrev_b32 v154, 4, v7
    s_lshl_b32 s8, s3, 7
    v_add_u32 v154, s8, v154
    v_add_u32 v155, 0, v6
    v_min_u32 v155, 27, v155
    v_lshl_add_u32 v179, v155, 9, v154
    v_add_u32 v155, 8, v6
    v_min_u32 v155, 27, v155
    v_lshl_add_u32 v180, v155, 9, v154
    v_add_u32 v155, 16, v6
    v_min_u32 v155, 27, v155
    v_lshl_add_u32 v181, v155, 9, v154
    v_add_u32 v155, 24, v6
    v_min_u32 v155, 27, v155
    v_lshl_add_u32 v182, v155, 9, v154
    v_lshlrev_b32 v178, 3, v6
    v_add_u32 v155, 24, v6
    v_min_u32 v155, 27, v155
    v_lshlrev_b32 v190, 3, v155
    v_cmp_gt_u32 vcc, 4, v6
    s_nop 1
    v_cndmask_b32 v191, 0, 1.0, vcc
    v_bfe_u32 v155, v0, 3, 1
    v_lshl_add_u32 v155, v7, 2, v155
    v_bfe_u32 v156, v0, 4, 1
    v_lshl_add_u32 v155, v156, 1, v155
    v_lshlrev_b32 v155, 1, v155
    s_lshl_b32 s8, s3, 6
    v_add_u32 v189, s8, v155
    v_lshlrev_b32 v155, 15, v1
    v_lshl_add_u32 v155, v2, 4, v155
    s_lshl_b32 s8, s3, 8
    v_add_u32 v183, s8, v155
    v_lshlrev_b32 v155, 4, v2
    v_lshl_add_u32 v155, v1, 3, v155
    v_add_u32 v188, s8, v155
    v_and_b32 v155, 31, v0
    v_lshlrev_b32 v155, 15, v155
    s_lshl_b32 s8, s3, 8
    s_add_u32 s8, s8, 252
    v_add_u32 v116, s8, v155
    s_lshl_b32 s8, s3, 4
    v_mov_b32 v112, s8
    v_and_b32 v155, 3, v0
    v_lshlrev_b32 v113, 4, v155
    s_lshl_b32 s8, s3, 8
    v_add_u32 v114, s8, v162
    v_add_u32 v115, s8, v167
    v_and_b32 v6, 7, v2
    v_lshrrev_b32 v7, 1, v6
    v_and_b32 v6, 1, v6
    v_mov_b32 v155, 0xffff
    v_mov_b32 v156, 0xffff0000
    v_cmp_eq_u32 vcc, 1, v6
    s_nop 1
    v_cndmask_b32 v6, v155, v156, vcc
    v_cmp_eq_u32 vcc, 0, v7
    s_nop 1
    v_cndmask_b32 v144, 0, v6, vcc
    v_and_b32 v184, 0x3f803f80, v144
    v_cmp_eq_u32 vcc, 1, v7
    s_nop 1
    v_cndmask_b32 v145, 0, v6, vcc
    v_and_b32 v185, 0x3f803f80, v145
    v_cmp_eq_u32 vcc, 2, v7
    s_nop 1
    v_cndmask_b32 v146, 0, v6, vcc
    v_and_b32 v186, 0x3f803f80, v146
    v_cmp_eq_u32 vcc, 3, v7
    s_nop 1
    v_cndmask_b32 v147, 0, v6, vcc
    v_and_b32 v187, 0x3f803f80, v147
    v_perm_b32 v16, v170, v170, v8
    v_perm_b32 v17, v170, v170, v9
    v_perm_b32 v18, v170, v170, v10
    v_perm_b32 v19, v170, v170, v11
    v_perm_b32 v20, v170, v170, v12
    v_perm_b32 v21, v170, v170, v13
    v_perm_b32 v22, v170, v170, v14
    v_perm_b32 v23, v170, v170, v15
    s_waitcnt vmcnt(23)
    v_mfma_f32_16x16x32_bf16 v[24:27], v[16:19], a[128:131], 0
    v_perm_b32 v16, v171, v171, v8
    v_perm_b32 v17, v171, v171, v9
    v_perm_b32 v18, v171, v171, v10
    v_perm_b32 v19, v171, v171, v11
    s_waitcnt vmcnt(22)
    v_mfma_f32_16x16x32_bf16 v[24:27], v[20:23], a[132:135], v[24:27]
    v_perm_b32 v20, v171, v171, v12
    v_perm_b32 v21, v171, v171, v13
    v_perm_b32 v22, v171, v171, v14
    v_perm_b32 v23, v171, v171, v15
    s_waitcnt vmcnt(21)
    v_mfma_f32_16x16x32_bf16 v[24:27], v[16:19], a[136:139], v[24:27]
    v_perm_b32 v16, v172, v172, v8
    v_perm_b32 v17, v172, v172, v9
    v_perm_b32 v18, v172, v172, v10
    v_perm_b32 v19, v172, v172, v11
    s_waitcnt vmcnt(20)
    v_mfma_f32_16x16x32_bf16 v[24:27], v[20:23], a[140:143], v[24:27]
    v_perm_b32 v20, v172, v172, v12
    v_perm_b32 v21, v172, v172, v13
    v_perm_b32 v22, v172, v172, v14
    v_perm_b32 v23, v172, v172, v15
    s_waitcnt vmcnt(19)
    v_mfma_f32_16x16x32_bf16 v[24:27], v[16:19], a[144:147], v[24:27]
    v_perm_b32 v16, v173, v173, v8
    v_perm_b32 v17, v173, v173, v9
    v_perm_b32 v18, v173, v173, v10
    v_perm_b32 v19, v173, v173, v11
    s_waitcnt vmcnt(18)
    v_mfma_f32_16x16x32_bf16 v[24:27], v[20:23], a[148:151], v[24:27]
    v_perm_b32 v20, v173, v173, v12
    v_perm_b32 v21, v173, v173, v13
    v_perm_b32 v22, v173, v173, v14
    v_perm_b32 v23, v173, v173, v15
    s_waitcnt vmcnt(17)
    v_mfma_f32_16x16x32_bf16 v[24:27], v[16:19], a[152:155], v[24:27]
    v_perm_b32 v16, v174, v174, v8
    v_perm_b32 v17, v174, v174, v9
    v_perm_b32 v18, v174, v174, v10
    v_perm_b32 v19, v174, v174, v11
    s_waitcnt vmcnt(16)
    v_mfma_f32_16x16x32_bf16 v[24:27], v[20:23], a[156:159], v[24:27]
    v_perm_b32 v20, v174, v174, v12
    v_perm_b32 v21, v174, v174, v13
    v_perm_b32 v22, v174, v174, v14
    v_perm_b32 v23, v174, v174, v15
    s_waitcnt vmcnt(15)
    v_mfma_f32_16x16x32_bf16 v[24:27], v[16:19], a[160:163], v[24:27]
    v_perm_b32 v16, v175, v175, v8
    v_perm_b32 v17, v175, v175, v9
    v_perm_b32 v18, v175, v175, v10
    v_perm_b32 v19, v175, v175, v11
    s_waitcnt vmcnt(14)
    v_mfma_f32_16x16x32_bf16 v[24:27], v[20:23], a[164:167], v[24:27]
    v_perm_b32 v20, v175, v175, v12
    v_perm_b32 v21, v175, v175, v13
    v_perm_b32 v22, v175, v175, v14
    v_perm_b32 v23, v175, v175, v15
    s_waitcnt vmcnt(13)
    v_mfma_f32_16x16x32_bf16 v[24:27], v[16:19], a[168:171], v[24:27]
    v_perm_b32 v16, v176, v176, v8
    v_perm_b32 v17, v176, v176, v9
    v_perm_b32 v18, v176, v176, v10
    v_perm_b32 v19, v176, v176, v11
    s_waitcnt vmcnt(12)
    v_mfma_f32_16x16x32_bf16 v[24:27], v[20:23], a[172:175], v[24:27]
    v_perm_b32 v20, v176, v176, v12
    v_perm_b32 v21, v176, v176, v13
    v_perm_b32 v22, v176, v176, v14
    v_perm_b32 v23, v176, v176, v15
    s_waitcnt vmcnt(11)
    v_mfma_f32_16x16x32_bf16 v[24:27], v[16:19], a[176:179], v[24:27]
    v_perm_b32 v16, v177, v177, v8
    v_perm_b32 v17, v177, v177, v9
    v_perm_b32 v18, v177, v177, v10
    v_perm_b32 v19, v177, v177, v11
    s_waitcnt vmcnt(10)
    v_mfma_f32_16x16x32_bf16 v[24:27], v[20:23], a[180:183], v[24:27]
    v_perm_b32 v20, v177, v177, v12
    v_perm_b32 v21, v177, v177, v13
    v_perm_b32 v22, v177, v177, v14
    v_perm_b32 v23, v177, v177, v15
    s_waitcnt vmcnt(9)
    v_mfma_f32_16x16x32_bf16 v[24:27], v[16:19], a[184:187], v[24:27]
    s_waitcnt vmcnt(8)
    v_mfma_f32_16x16x32_bf16 v[24:27], v[20:23], a[188:191], v[24:27]
    s_mov_b32 exec_lo, 0x00ff00ff
    s_mov_b32 exec_hi, 0xff00ff00
    s_nop 5
    ds_write_b128 v157, v[24:27] offset:8192
    s_mov_b64 exec, -1
    s_waitcnt lgkmcnt(0)
    s_barrier
    s_cmp_lg_u32 s3, 0
    s_cbranch_scc1 L_w0_18
    v_and_b32 v6, 31, v0
    v_lshlrev_b32 v6, 3, v6
    ds_read_b64 v[66:67], v6 offset:8192
    ds_read_b64 v[68:69], v6 offset:8448
    ds_read_b64 v[70:71], v6 offset:8704
    ds_read_b64 v[72:73], v6 offset:8960
    ds_read_b64 v[74:75], v6 offset:9216
    ds_read_b64 v[76:77], v6 offset:9472
    ds_read_b64 v[78:79], v6 offset:9728
    ds_read_b64 v[80:81], v6 offset:9984
    s_waitcnt lgkmcnt(0)
    v_pk_add_f32 v[66:67], v[66:67], v[74:75]
    v_pk_add_f32 v[68:69], v[68:69], v[76:77]
    v_pk_add_f32 v[70:71], v[70:71], v[78:79]
    v_pk_add_f32 v[72:73], v[72:73], v[80:81]
    v_pk_add_f32 v[66:67], v[66:67], v[70:71]
    v_pk_add_f32 v[68:69], v[68:69], v[72:73]
    v_pk_add_f32 v[66:67], v[66:67], v[68:69]
    v_cvt_pk_bf16_f32 v54, v66, v67
    s_add_u32 s9, s15, 0
    v_mov_b32 v55, v3
    s_lshl_b32 s8, s9, 8
    s_add_u32 s8, s8, 4096
    v_lshlrev_b32 v154, 3, v0
    s_mov_b32 exec_hi, 0
    buffer_store_dwordx2 v[54:55], v154, s[52:55], s8 offen sc1
    s_mov_b64 exec, -1
L_w0_18:
    s_cmp_lg_u32 s3, 0
    s_cbranch_scc1 L_w0_19
    s_getreg_b32 s8, hwreg(HW_REG_XCC_ID)
    s_and_b32 s8, s8, 15
    v_mov_b32 v56, s8
    v_mov_b32 v57, v3
    s_lshl_b32 s8, s4, 3
    s_add_u32 s8, s8, 16384
    v_mov_b32 v154, 0
    s_mov_b64 exec, 1
    buffer_store_dwordx2 v[56:57], v154, s[52:55], s8 offen sc1
    s_mov_b64 exec, -1
L_w0_19:
    buffer_load_dwordx4 a[32:35], v153, s[48:51], s10 offen offset:0 nt
    buffer_load_dwordx4 a[36:39], v153, s[48:51], s10 offen offset:1024 nt
    buffer_load_dwordx4 a[40:43], v153, s[48:51], s10 offen offset:2048 nt
    buffer_load_dwordx4 a[44:47], v153, s[48:51], s10 offen offset:3072 nt
    s_add_u32 s10, s10, 4096
    buffer_load_dwordx4 a[48:51], v153, s[48:51], s10 offen offset:0 nt
    buffer_load_dwordx4 a[52:55], v153, s[48:51], s10 offen offset:1024 nt
    buffer_load_dwordx4 a[56:59], v153, s[48:51], s10 offen offset:2048 nt
    buffer_load_dwordx4 a[60:63], v153, s[48:51], s10 offen offset:3072 nt
    s_add_u32 s10, s10, 4096
    buffer_load_dwordx4 a[64:67], v153, s[48:51], s10 offen offset:0 nt
    buffer_load_dwordx4 a[68:71], v153, s[48:51], s10 offen offset:1024 nt
    buffer_load_dwordx4 a[72:75], v153, s[48:51], s10 offen offset:2048 nt
    buffer_load_dwordx4 a[76:79], v153, s[48:51], s10 offen offset:3072 nt
    s_add_u32 s10, s10, 4096
    buffer_load_dwordx4 a[80:83], v153, s[48:51], s10 offen offset:0 nt
    buffer_load_dwordx4 a[84:87], v153, s[48:51], s10 offen offset:1024 nt
    buffer_load_dwordx4 a[88:91], v153, s[48:51], s10 offen offset:2048 nt
    buffer_load_dwordx4 a[92:95], v153, s[48:51], s10 offen offset:3072 nt
    s_add_u32 s10, s10, 4096
    buffer_load_dwordx4 a[96:99], v153, s[48:51], s10 offen offset:0 nt
    buffer_load_dwordx4 a[100:103], v153, s[48:51], s10 offen offset:1024 nt
    buffer_load_dwordx4 a[104:107], v153, s[48:51], s10 offen offset:2048 nt
    buffer_load_dwordx4 a[108:111], v153, s[48:51], s10 offen offset:3072 nt
    s_add_u32 s10, s10, 4096
    buffer_load_dwordx4 a[112:115], v153, s[48:51], s10 offen offset:0 nt
    buffer_load_dwordx4 a[116:119], v153, s[48:51], s10 offen offset:1024 nt
    buffer_load_dwordx4 a[120:123], v153, s[48:51], s10 offen offset:2048 nt
    buffer_load_dwordx4 a[124:127], v153, s[48:51], s10 offen offset:3072 nt
    s_cmp_ge_u32 s11, 22
    s_cbranch_scc1 L_noffn_20
    v_lshrrev_b32 v6, 3, v2
    v_lshl_add_u32 v6, v1, 1, v6
    v_mul_u32_u24 v6, 44032, v6
    v_and_b32 v7, 7, v2
    v_lshl_add_u32 v169, v7, 4, v6
    s_mov_b32 s44, s28
    s_mov_b32 s45, s29
    s_mov_b32 s46, 1409024
    s_mov_b32 s47, 0x20000
    s_lshl_b32 s9, s11, 7
    s_mul_i32 s8, s3, 352256
    s_add_u32 s8, s8, s9
    buffer_load_dwordx4 a[192:195], v169, s[44:47], s8 offen
    s_add_u32 s8, s8, 2752
    buffer_load_dwordx4 a[196:199], v169, s[44:47], s8 offen
    s_add_u32 s8, s8, 2752
    buffer_load_dwordx4 a[200:203], v169, s[44:47], s8 offen
    s_add_u32 s8, s8, 2752
    buffer_load_dwordx4 a[204:207], v169, s[44:47], s8 offen
    s_add_u32 s8, s8, 2752
    buffer_load_dwordx4 a[208:211], v169, s[44:47], s8 offen
    s_add_u32 s8, s8, 2752
    buffer_load_dwordx4 a[212:215], v169, s[44:47], s8 offen
    s_add_u32 s8, s8, 2752
    buffer_load_dwordx4 a[216:219], v169, s[44:47], s8 offen
    s_add_u32 s8, s8, 2752
    buffer_load_dwordx4 a[220:223], v169, s[44:47], s8 offen
    s_add_u32 s8, s8, 2752
    buffer_load_dwordx4 a[224:227], v169, s[44:47], s8 offen
    s_add_u32 s8, s8, 2752
    buffer_load_dwordx4 a[228:231], v169, s[44:47], s8 offen
    s_add_u32 s8, s8, 2752
    buffer_load_dwordx4 a[232:235], v169, s[44:47], s8 offen
    s_add_u32 s8, s8, 2752
    buffer_load_dwordx4 a[236:239], v169, s[44:47], s8 offen
    s_add_u32 s8, s8, 2752
    buffer_load_dwordx4 a[240:243], v169, s[44:47], s8 offen
    s_add_u32 s8, s8, 2752
    buffer_load_dwordx4 a[244:247], v169, s[44:47], s8 offen
    s_add_u32 s8, s8, 2752
    buffer_load_dwordx4 a[248:251], v169, s[44:47], s8 offen
    s_add_u32 s8, s8, 2752
    buffer_load_dwordx4 a[252:255], v169, s[44:47], s8 offen
    s_mov_b32 s44, s30
    s_mov_b32 s45, s31
    s_mov_b32 s46, 1409024
    s_mov_b32 s47, 0x20000
    v_lshlrev_b32 v6, 14, v1
    v_lshl_add_u32 v153, v2, 4, v6
    s_lshl_b32 s8, s11, 16
    s_lshl_b32 s9, s3, 8
    s_add_u32 s8, s8, s9
    buffer_load_dwordx4 v[192:195], v153, s[44:47], s8 offen offset:0 nt
    buffer_load_dwordx4 v[196:199], v153, s[44:47], s8 offen offset:1024 nt
    buffer_load_dwordx4 v[200:203], v153, s[44:47], s8 offen offset:2048 nt
    buffer_load_dwordx4 v[204:207], v153, s[44:47], s8 offen offset:3072 nt
    s_add_u32 s8, s8, 4096
    buffer_load_dwordx4 v[208:211], v153, s[44:47], s8 offen offset:0 nt
    buffer_load_dwordx4 v[212:215], v153, s[44:47], s8 offen offset:1024 nt
    buffer_load_dwordx4 v[216:219], v153, s[44:47], s8 offen offset:2048 nt
    buffer_load_dwordx4 v[220:223], v153, s[44:47], s8 offen offset:3072 nt
    s_add_u32 s8, s8, 4096
    buffer_load_dwordx4 v[224:227], v153, s[44:47], s8 offen offset:0 nt
    buffer_load_dwordx4 v[228:231], v153, s[44:47], s8 offen offset:1024 nt
    buffer_load_dwordx4 v[232:235], v153, s[44:47], s8 offen offset:2048 nt
    buffer_load_dwordx4 v[236:239], v153, s[44:47], s8 offen offset:3072 nt
    s_add_u32 s8, s8, 4096
    buffer_load_dwordx4 v[240:243], v153, s[44:47], s8 offen offset:0 nt
    buffer_load_dwordx4 v[244:247], v153, s[44:47], s8 offen offset:1024 nt
    buffer_load_dwordx4 v[248:251], v153, s[44:47], s8 offen offset:2048 nt
    buffer_load_dwordx4 v[252:255], v153, s[44:47], s8 offen offset:3072 nt
L_noffn_20:
    v_lshlrev_b32 v154, 1, v5
    v_and_b32 v6, 31, v0
    v_lshlrev_b32 v155, 3, v6
    s_mov_b32 s43, 0
L_poll_m2:
    s_mov_b32 s8, 8192
    buffer_load_dwordx2 v[80:81], v154, s[52:55], s8 offen sc1
    s_mov_b32 s8, 10240
    buffer_load_dwordx2 v[82:83], v154, s[52:55], s8 offen sc1
    s_mov_b32 s8, 12288
    buffer_load_dwordx2 v[84:85], v154, s[52:55], s8 offen sc1
    s_mov_b32 s8, 14336
    buffer_load_dwordx2 v[86:87], v154, s[52:55], s8 offen sc1
    s_mov_b32 s8, 16384
    buffer_load_dwordx2 v[88:89], v155, s[52:55], s8 offen sc1
    s_waitcnt vmcnt(0)
    v_xor_b32 v6, v81, v3
    v_xor_b32 v7, v83, v3
    v_or_b32 v6, v6, v7
    v_xor_b32 v7, v85, v3
    v_or_b32 v6, v6, v7
    v_xor_b32 v7, v87, v3
    v_or_b32 v6, v6, v7
    v_xor_b32 v7, v89, v3
    v_or_b32 v6, v6, v7
    v_cmp_ne_u32 vcc, 0, v6
    s_cbranch_vccz L_poll_m2_ok
    s_add_u32 s43, s43, 1
    s_cmp_le_u32 s43, s42
    s_nop 1
    s_cbranch_scc1 L_poll_m2
L_poll_m2_ok:
    v_lshlrev_b32 v46, 16, v80
    v_and_b32 v47, 0xffff0000, v80
    v_lshlrev_b32 v48, 16, v82
    v_and_b32 v49, 0xffff0000, v82
    v_lshlrev_b32 v50, 16, v84
    v_and_b32 v51, 0xffff0000, v84
    v_add_f32 v50, 1.0, v50
    v_add_f32 v51, 1.0, v51
    v_cvt_pk_bf16_f32 v6, v50, v51
    v_lshlrev_b32 v50, 16, v6
    v_and_b32 v51, 0xffff0000, v6
    v_lshlrev_b32 v160, 16, v86
    v_and_b32 v161, 0xffff0000, v86
    s_getreg_b32 s8, hwreg(HW_REG_XCC_ID)
    s_and_b32 s8, s8, 15
    v_cmp_ne_u32 vcc, s8, v88
    s_mov_b32 s13, 1
    s_cbranch_vccz L_fast
    s_mov_b32 s13, 0
L_fast:
    s_mov_b32 s96, s36
    s_mov_b32 s97, s37
    s_mov_b32 s98, 1024
    s_mov_b32 s99, 0x20000
    s_add_u32 s8, s14, 16384
    s_add_u32 s9, s14, 0
    s_mov_b32 s43, 0
L_t1:
    buffer_load_dwordx2 v[96:97], v178, s[52:55], s8 offen offset:0 sc1
    buffer_load_dwordx2 v[98:99], v178, s[52:55], s8 offen offset:64 sc1
    buffer_load_dwordx2 v[100:101], v178, s[52:55], s8 offen offset:128 sc1
    buffer_load_dwordx2 v[102:103], v190, s[52:55], s8 offen sc1
    s_waitcnt vmcnt(0)
    v_max3_u32 v6, v96, v97, v98
    v_max3_u32 v7, v99, v100, v101
    v_max3_u32 v6, v6, v102, v103
    v_max_u32 v6, v6, v7
    v_cmp_eq_u32 vcc, -1, v6
    s_cbranch_vccz L_t1_ml
    s_add_u32 s43, s43, 1
    s_cmp_le_u32 s43, s42
    s_nop 1
    s_cbranch_scc1 L_t1
L_t1_ml:
    buffer_load_dwordx4 v[80:83], v179, s[52:55], s9 offen sc1
    buffer_load_dwordx4 v[84:87], v180, s[52:55], s9 offen sc1
    buffer_load_dwordx4 v[88:91], v181, s[52:55], s9 offen sc1
    buffer_load_dwordx4 v[92:95], v182, s[52:55], s9 offen sc1
    v_max3_f32 v64, v96, v98, v100
    v_max_f32 v64, v64, v102
    s_nop 1
    v_max_f32_dpp v64, v64, v64 row_ror:8 row_mask:0xf bank_mask:0xf
    v_mov_b32 v6, v64
    s_nop 1
    v_permlane16_swap_b32 v64, v6
    v_max_f32 v64, v64, v6
    v_mov_b32 v6, v64
    s_nop 1
    v_permlane32_swap_b32 v64, v6
    v_max_f32 v64, v64, v6
    v_sub_f32 v104, v96, v64
    v_sub_f32 v106, v98, v64
    v_sub_f32 v108, v100, v64
    v_sub_f32 v110, v102, v64
    v_mul_f32 v104, 0x3fb8aa3b, v104
    v_mul_f32 v106, 0x3fb8aa3b, v106
    v_mul_f32 v108, 0x3fb8aa3b, v108
    v_mul_f32 v110, 0x3fb8aa3b, v110
    v_exp_f32 v104, v104
    v_exp_f32 v106, v106
    v_exp_f32 v108, v108
    v_exp_f32 v110, v110
    s_nop 0
    v_mul_f32 v110, v110, v191
    s_waitcnt vmcnt(0)
    v_max3_u32 v6, v80, v81, v82
    v_max3_u32 v7, v83, v84, v85
    v_max3_u32 v6, v6, v86, v87
    v_max3_u32 v7, v7, v88, v89
    v_max3_u32 v6, v6, v90, v91
    v_max3_u32 v7, v7, v92, v93
    v_max3_u32 v6, v6, v94, v95
    v_max_u32 v6, v6, v7
    v_cmp_eq_u32 vcc, -1, v6
    s_cbranch_vccz L_t1_ok
L_t1b:
    buffer_load_dwordx4 v[80:83], v179, s[52:55], s9 offen sc1
    buffer_load_dwordx4 v[84:87], v180, s[52:55], s9 offen sc1
    buffer_load_dwordx4 v[88:91], v181, s[52:55], s9 offen sc1
    buffer_load_dwordx4 v[92:95], v182, s[52:55], s9 offen sc1
    s_waitcnt vmcnt(0)
    v_max3_u32 v6, v80, v81, v82
    v_max3_u32 v7, v83, v84, v85
    v_max3_u32 v6, v6, v86, v87
    v_max3_u32 v7, v7, v88, v89
    v_max3_u32 v6, v6, v90, v91
    v_max3_u32 v7, v7, v92, v93
    v_max3_u32 v6, v6, v94, v95
    v_max_u32 v6, v6, v7
    v_cmp_eq_u32 vcc, -1, v6
    s_cbranch_vccz L_t1_ok
    s_add_u32 s43, s43, 1
    s_cmp_le_u32 s43, s42
    s_nop 1
    s_cbranch_scc1 L_t1b
L_t1_ok:
    v_pk_mul_f32 v[54:55], v[80:81], v[104:105] op_sel_hi:[1,0]
    v_pk_mul_f32 v[56:57], v[82:83], v[104:105] op_sel_hi:[1,0]
    v_mul_f32 v62, v104, v97
    v_pk_fma_f32 v[54:55], v[84:85], v[106:107], v[54:55] op_sel_hi:[1,0,1]
    v_pk_fma_f32 v[56:57], v[86:87], v[106:107], v[56:57] op_sel_hi:[1,0,1]
    v_fmac_f32 v62, v106, v99
    v_pk_fma_f32 v[54:55], v[88:89], v[108:109], v[54:55] op_sel_hi:[1,0,1]
    v_pk_fma_f32 v[56:57], v[90:91], v[108:109], v[56:57] op_sel_hi:[1,0,1]
    v_fmac_f32 v62, v108, v101
    v_pk_fma_f32 v[54:55], v[92:93], v[110:111], v[54:55] op_sel_hi:[1,0,1]
    v_pk_fma_f32 v[56:57], v[94:95], v[110:111], v[56:57] op_sel_hi:[1,0,1]
    v_fmac_f32 v62, v110, v103
    v_add_f32_dpp v58, v54, v54 row_ror:8 row_mask:0xf bank_mask:0x3
    v_add_f32_dpp v59, v56, v56 row_ror:8 row_mask:0xf bank_mask:0x3
    v_add_f32_dpp v62, v62, v62 row_ror:8 row_mask:0xf bank_mask:0xf
    v_add_f32_dpp v58, v55, v55 row_ror:8 row_mask:0xf bank_mask:0xc
    v_add_f32_dpp v59, v57, v57 row_ror:8 row_mask:0xf bank_mask:0xc
    v_mov_b32 v63, v62
    s_nop 1
    v_permlane16_swap_b32 v62, v63
    v_permlane16_swap_b32 v58, v59
    v_add_f32 v62, v62, v63
    v_add_f32 v58, v58, v59
    v_mov_b32 v63, v62
    v_mov_b32 v59, v58
    s_nop 0
    v_permlane32_swap_b32 v62, v63
    v_permlane32_swap_b32 v58, v59
    v_add_f32 v62, v62, v63
    v_add_f32 v58, v58, v59
    v_rcp_f32 v62, v62
    s_nop 0
    v_mul_f32 v58, v58, v62
    v_cvt_pk_bf16_f32 v58, v58, v58
    ds_write_b16 v189, v58 offset:3584
    s_waitcnt lgkmcnt(0)
    s_barrier
    ds_read_b128 v[28:31], v168 offset:3584
    ds_read_b128 v[32:35], v168 offset:3600
    ds_read_b128 v[36:39], v168 offset:3616
    ds_read_b128 v[40:43], v168 offset:3632
    s_add_u32 s8, s14, 17408
    s_waitcnt lgkmcnt(0)
    v_perm_b32 v16, v28, v28, v8
    v_perm_b32 v17, v28, v28, v9
    v_perm_b32 v18, v28, v28, v10
    v_perm_b32 v19, v28, v28, v11
    v_perm_b32 v20, v28, v28, v12
    v_perm_b32 v21, v28, v28, v13
    v_perm_b32 v22, v28, v28, v14
    v_perm_b32 v23, v28, v28, v15
    v_mfma_f32_16x16x32_bf16 v[24:27], v[16:19], a[0:3], 0
    v_perm_b32 v16, v29, v29, v8
    v_perm_b32 v17, v29, v29, v9
    v_perm_b32 v18, v29, v29, v10
    v_perm_b32 v19, v29, v29, v11
    v_mfma_f32_16x16x32_bf16 v[24:27], v[20:23], a[4:7], v[24:27]
    v_perm_b32 v20, v29, v29, v12
    v_perm_b32 v21, v29, v29, v13
    v_perm_b32 v22, v29, v29, v14
    v_perm_b32 v23, v29, v29, v15
    v_mfma_f32_16x16x32_bf16 v[24:27], v[16:19], a[8:11], v[24:27]
    v_perm_b32 v16, v30, v30, v8
    v_perm_b32 v17, v30, v30, v9
    v_perm_b32 v18, v30, v30, v10
    v_perm_b32 v19, v30, v30, v11
    v_mfma_f32_16x16x32_bf16 v[24:27], v[20:23], a[12:15], v[24:27]
    v_perm_b32 v20, v30, v30, v12
    v_perm_b32 v21, v30, v30, v13
    v_perm_b32 v22, v30, v30, v14
    v_perm_b32 v23, v30, v30, v15
    v_mfma_f32_16x16x32_bf16 v[24:27], v[16:19], a[16:19], v[24:27]
    v_perm_b32 v16, v31, v31, v8
    v_perm_b32 v17, v31, v31, v9
    v_perm_b32 v18, v31, v31, v10
    v_perm_b32 v19, v31, v31, v11
    v_mfma_f32_16x16x32_bf16 v[24:27], v[20:23], a[20:23], v[24:27]
    v_perm_b32 v20, v31, v31, v12
    v_perm_b32 v21, v31, v31, v13
    v_perm_b32 v22, v31, v31, v14
    v_perm_b32 v23, v31, v31, v15
    v_mfma_f32_16x16x32_bf16 v[24:27], v[16:19], a[24:27], v[24:27]
    v_perm_b32 v16, v32, v32, v8
    v_perm_b32 v17, v32, v32, v9
    v_perm_b32 v18, v32, v32, v10
    v_perm_b32 v19, v32, v32, v11
    v_mfma_f32_16x16x32_bf16 v[24:27], v[20:23], a[28:31], v[24:27]
    v_perm_b32 v20, v32, v32, v12
    v_perm_b32 v21, v32, v32, v13
    v_perm_b32 v22, v32, v32, v14
    v_perm_b32 v23, v32, v32, v15
    v_mfma_f32_16x16x32_bf16 v[24:27], v[16:19], a[32:35], v[24:27]
    v_perm_b32 v16, v33, v33, v8
    v_perm_b32 v17, v33, v33, v9
    v_perm_b32 v18, v33, v33, v10
    v_perm_b32 v19, v33, v33, v11
    v_mfma_f32_16x16x32_bf16 v[24:27], v[20:23], a[36:39], v[24:27]
    v_perm_b32 v20, v33, v33, v12
    v_perm_b32 v21, v33, v33, v13
    v_perm_b32 v22, v33, v33, v14
    v_perm_b32 v23, v33, v33, v15
    v_mfma_f32_16x16x32_bf16 v[24:27], v[16:19], a[40:43], v[24:27]
    v_perm_b32 v16, v34, v34, v8
    v_perm_b32 v17, v34, v34, v9
    v_perm_b32 v18, v34, v34, v10
    v_perm_b32 v19, v34, v34, v11
    v_mfma_f32_16x16x32_bf16 v[24:27], v[20:23], a[44:47], v[24:27]
    v_perm_b32 v20, v34, v34, v12
    v_perm_b32 v21, v34, v34, v13
    v_perm_b32 v22, v34, v34, v14
    v_perm_b32 v23, v34, v34, v15
    v_mfma_f32_16x16x32_bf16 v[24:27], v[16:19], a[48:51], v[24:27]
    v_perm_b32 v16, v35, v35, v8
    v_perm_b32 v17, v35, v35, v9
    v_perm_b32 v18, v35, v35, v10
    v_perm_b32 v19, v35, v35, v11
    v_mfma_f32_16x16x32_bf16 v[24:27], v[20:23], a[52:55], v[24:27]
    v_perm_b32 v20, v35, v35, v12
    v_perm_b32 v21, v35, v35, v13
    v_perm_b32 v22, v35, v35, v14
    v_perm_b32 v23, v35, v35, v15
    v_mfma_f32_16x16x32_bf16 v[24:27], v[16:19], a[56:59], v[24:27]
    v_perm_b32 v16, v36, v36, v8
    v_perm_b32 v17, v36, v36, v9
    v_perm_b32 v18, v36, v36, v10
    v_perm_b32 v19, v36, v36, v11
    v_mfma_f32_16x16x32_bf16 v[24:27], v[20:23], a[60:63], v[24:27]
    v_perm_b32 v20, v36, v36, v12
    v_perm_b32 v21, v36, v36, v13
    v_perm_b32 v22, v36, v36, v14
    v_perm_b32 v23, v36, v36, v15
    v_mfma_f32_16x16x32_bf16 v[24:27], v[16:19], a[64:67], v[24:27]
    v_perm_b32 v16, v37, v37, v8
    v_perm_b32 v17, v37, v37, v9
    v_perm_b32 v18, v37, v37, v10
    v_perm_b32 v19, v37, v37, v11
    v_mfma_f32_16x16x32_bf16 v[24:27], v[20:23], a[68:71], v[24:27]
    v_perm_b32 v20, v37, v37, v12
    v_perm_b32 v21, v37, v37, v13
    v_perm_b32 v22, v37, v37, v14
    v_perm_b32 v23, v37, v37, v15
    v_mfma_f32_16x16x32_bf16 v[24:27], v[16:19], a[72:75], v[24:27]
    v_perm_b32 v16, v38, v38, v8
    v_perm_b32 v17, v38, v38, v9
    v_perm_b32 v18, v38, v38, v10
    v_perm_b32 v19, v38, v38, v11
    v_mfma_f32_16x16x32_bf16 v[24:27], v[20:23], a[76:79], v[24:27]
    v_perm_b32 v20, v38, v38, v12
    v_perm_b32 v21, v38, v38, v13
    v_perm_b32 v22, v38, v38, v14
    v_perm_b32 v23, v38, v38, v15
    v_mfma_f32_16x16x32_bf16 v[24:27], v[16:19], a[80:83], v[24:27]
    v_perm_b32 v16, v39, v39, v8
    v_perm_b32 v17, v39, v39, v9
    v_perm_b32 v18, v39, v39, v10
    v_perm_b32 v19, v39, v39, v11
    v_mfma_f32_16x16x32_bf16 v[24:27], v[20:23], a[84:87], v[24:27]
    v_perm_b32 v20, v39, v39, v12
    v_perm_b32 v21, v39, v39, v13
    v_perm_b32 v22, v39, v39, v14
    v_perm_b32 v23, v39, v39, v15
    v_mfma_f32_16x16x32_bf16 v[24:27], v[16:19], a[88:91], v[24:27]
    v_perm_b32 v16, v40, v40, v8
    v_perm_b32 v17, v40, v40, v9
    v_perm_b32 v18, v40, v40, v10
    v_perm_b32 v19, v40, v40, v11
    v_mfma_f32_16x16x32_bf16 v[24:27], v[20:23], a[92:95], v[24:27]
    v_perm_b32 v20, v40, v40, v12
    v_perm_b32 v21, v40, v40, v13
    v_perm_b32 v22, v40, v40, v14
    v_perm_b32 v23, v40, v40, v15
    v_mfma_f32_16x16x32_bf16 v[24:27], v[16:19], a[96:99], v[24:27]
    v_perm_b32 v16, v41, v41, v8
    v_perm_b32 v17, v41, v41, v9
    v_perm_b32 v18, v41, v41, v10
    v_perm_b32 v19, v41, v41, v11
    v_mfma_f32_16x16x32_bf16 v[24:27], v[20:23], a[100:103], v[24:27]
    v_perm_b32 v20, v41, v41, v12
    v_perm_b32 v21, v41, v41, v13
    v_perm_b32 v22, v41, v41, v14
    v_perm_b32 v23, v41, v41, v15
    v_mfma_f32_16x16x32_bf16 v[24:27], v[16:19], a[104:107], v[24:27]
    v_perm_b32 v16, v42, v42, v8
    v_perm_b32 v17, v42, v42, v9
    v_perm_b32 v18, v42, v42, v10
    v_perm_b32 v19, v42, v42, v11
    v_mfma_f32_16x16x32_bf16 v[24:27], v[20:23], a[108:111], v[24:27]
    v_perm_b32 v20, v42, v42, v12
    v_perm_b32 v21, v42, v42, v13
    v_perm_b32 v22, v42, v42, v14
    v_perm_b32 v23, v42, v42, v15
    v_mfma_f32_16x16x32_bf16 v[24:27], v[16:19], a[112:115], v[24:27]
    v_perm_b32 v16, v43, v43, v8
    v_perm_b32 v17, v43, v43, v9
    v_perm_b32 v18, v43, v43, v10
    v_perm_b32 v19, v43, v43, v11
    v_mfma_f32_16x16x32_bf16 v[24:27], v[20:23], a[116:119], v[24:27]
    v_perm_b32 v20, v43, v43, v12
    v_perm_b32 v21, v43, v43, v13
    v_perm_b32 v22, v43, v43, v14
    v_perm_b32 v23, v43, v43, v15
    v_mfma_f32_16x16x32_bf16 v[24:27], v[16:19], a[120:123], v[24:27]
    s_nop 0
    v_mfma_f32_16x16x32_bf16 v[24:27], v[20:23], a[124:127], v[24:27]
    s_nop 7
    v_cvt_pk_bf16_f32 v54, v24, v25
    v_cvt_pk_bf16_f32 v55, v26, v27
    s_mov_b32 exec_hi, 0
    s_cmp_eq_u32 s13, 1
    s_cbranch_scc0 L_slow_21
    buffer_store_dwordx2 v[54:55], v188, s[52:55], s8 offen
    s_branch L_pub_22
L_slow_21:
    buffer_store_dwordx2 v[54:55], v188, s[52:55], s8 offen sc1
L_pub_22:
    s_mov_b64 exec, -1
    s_cmp_lt_u32 s11, 22
    s_cbranch_scc1 L_t3_go
    s_cmp_lg_u32 s4, 23
    s_cbranch_scc1 L_fin
L_t3_go:
    s_mov_b32 s43, 0
L_t3:
    s_mov_b32 s8, 82944
    buffer_load_dwordx4 v[80:83], v183, s[52:55], s8 offen sc1
    s_mov_b32 s8, 214016
    buffer_load_dwordx4 v[84:87], v183, s[52:55], s8 offen sc1
    s_mov_b32 s8, 345088
    buffer_load_dwordx4 v[88:91], v183, s[52:55], s8 offen sc1
    s_mov_b32 s8, 476160
    buffer_load_dwordx4 v[92:95], v183, s[52:55], s8 offen sc1
    s_mov_b32 s8, 607232
    buffer_load_dwordx4 v[96:99], v183, s[52:55], s8 offen sc1
    s_mov_b32 s8, 738304
    buffer_load_dwordx4 v[100:103], v183, s[52:55], s8 offen sc1
    s_mov_b32 s8, 869376
    buffer_load_dwordx4 v[104:107], v183, s[52:55], s8 offen sc1
    s_mov_b32 s8, 1000448
    buffer_load_dwordx4 v[108:111], v183, s[52:55], s8 offen sc1
    s_waitcnt vmcnt(7)
    v_mfma_f32_16x16x32_bf16 v[24:27], v[184:187], v[80:83], 0
    s_waitcnt vmcnt(6)
    v_mfma_f32_16x16x32_bf16 v[24:27], v[184:187], v[84:87], v[24:27]
    s_waitcnt vmcnt(5)
    v_mfma_f32_16x16x32_bf16 v[24:27], v[184:187], v[88:91], v[24:27]
    s_waitcnt vmcnt(4)
    v_mfma_f32_16x16x32_bf16 v[24:27], v[184:187], v[92:95], v[24:27]
    s_waitcnt vmcnt(3)
    v_mfma_f32_16x16x32_bf16 v[24:27], v[184:187], v[96:99], v[24:27]
    s_waitcnt vmcnt(2)
    v_mfma_f32_16x16x32_bf16 v[24:27], v[184:187], v[100:103], v[24:27]
    s_waitcnt vmcnt(1)
    v_mfma_f32_16x16x32_bf16 v[24:27], v[184:187], v[104:107], v[24:27]
    s_waitcnt vmcnt(0)
    v_mfma_f32_16x16x32_bf16 v[24:27], v[184:187], v[108:111], v[24:27]
    s_nop 7
    v_pk_add_f32 v[54:55], v[24:25], v[26:27]
    v_cmp_u_f32 vcc, v54, v55
    s_cbranch_vccz L_t3_ok
    s_add_u32 s43, s43, 1
    s_cmp_le_u32 s43, s42
    s_nop 1
    s_cbranch_scc1 L_t3
L_t3_ok:
    v_permlane32_swap_b32 v24, v26
    v_permlane32_swap_b32 v25, v27
    v_cvt_pk_bf16_f32 v6, v24, v25
    v_lshlrev_b32 v24, 16, v6
    v_and_b32 v25, 0xffff0000, v6
    v_pk_mul_f32 v[24:25], v[46:47], v[24:25]
    v_cvt_pk_bf16_f32 v6, v24, v25
    v_lshlrev_b32 v24, 16, v6
    v_and_b32 v25, 0xffff0000, v6
    v_pk_add_f32 v[52:53], v[44:45], v[24:25]
    v_cvt_pk_bf16_f32 v6, v52, v53
    v_lshlrev_b32 v52, 16, v6
    v_and_b32 v53, 0xffff0000, v6
    s_cmp_eq_u32 s4, 23
    s_cbranch_scc1 L_final
    v_readfirstlane_b32 s8, v52
    s_nop 1
    v_subrev_f32 v70, s8, v52
    v_subrev_f32 v71, s8, v53
    v_add_f32 v66, v70, v71
    v_mul_f32 v67, v70, v70
    v_fmac_f32 v67, v71, v71
    v_mov_b32 v68, s8
    v_add_f32_dpp v66, v66, v66 quad_perm:[1,0,3,2] row_mask:0xf bank_mask:0xf
    v_add_f32_dpp v67, v67, v67 quad_perm:[1,0,3,2] row_mask:0xf bank_mask:0xf
    s_nop 0
    v_add_f32_dpp v66, v66, v66 quad_perm:[2,3,0,1] row_mask:0xf bank_mask:0xf
    v_add_f32_dpp v67, v67, v67 quad_perm:[2,3,0,1] row_mask:0xf bank_mask:0xf
    s_nop 0
    v_add_f32_dpp v66, v66, v66 row_ror:4 row_mask:0xf bank_mask:0xf
    v_add_f32_dpp v67, v67, v67 row_ror:4 row_mask:0xf bank_mask:0xf
    s_nop 0
    v_add_f32_dpp v66, v66, v66 row_ror:8 row_mask:0xf bank_mask:0xf
    v_add_f32_dpp v67, v67, v67 row_ror:8 row_mask:0xf bank_mask:0xf
    s_nop 0
    v_add_f32_dpp v66, v66, v66 row_bcast:15 row_mask:0xa bank_mask:0xf
    v_add_f32_dpp v67, v67, v67 row_bcast:15 row_mask:0xa bank_mask:0xf
    s_nop 0
    v_add_f32_dpp v66, v66, v66 row_bcast:31 row_mask:0xc bank_mask:0xf
    v_add_f32_dpp v67, v67, v67 row_bcast:31 row_mask:0xc bank_mask:0xf
    s_mov_b32 exec_lo, 0
    s_mov_b32 exec_hi, 0x80000000
    ds_write_b128 v112, v[66:69] offset:3904
    s_mov_b64 exec, -1
    s_waitcnt lgkmcnt(0)
    s_barrier
    ds_read_b128 v[70:73], v113 offset:3904
    s_nop 0
    s_waitcnt lgkmcnt(0)
    v_mul_f32 v66, 0x3c000000, v70
    v_add_f32 v67, v66, v72
    v_fma_f32 v68, -v66, v70, v71
    s_nop 0
    v_add_f32_dpp v70, v67, v67 quad_perm:[1,0,3,2] row_mask:0xf bank_mask:0xf
    s_nop 1
    v_add_f32_dpp v70, v70, v70 quad_perm:[2,3,0,1] row_mask:0xf bank_mask:0xf
    v_mul_f32 v70, 0x3e800000, v70
    v_sub_f32 v67, v67, v70
    v_mul_f32 v66, 0x43000000, v67
    v_fma_f32 v68, v66, v67, v68
    s_nop 1
    v_add_f32_dpp v71, v68, v68 quad_perm:[1,0,3,2] row_mask:0xf bank_mask:0xf
    s_nop 1
    v_add_f32_dpp v71, v71, v71 quad_perm:[2,3,0,1] row_mask:0xf bank_mask:0xf
    v_mul_f32 v71, 0x3b000000, v71
    v_max_f32 v71, 0, v71
    v_cvt_pk_bf16_f32 v6, v70, v71
    v_lshlrev_b32 v70, 16, v6
    v_and_b32 v71, 0xffff0000, v6
    v_add_f32 v71, 0x3727c5ac, v71
    v_cvt_pk_bf16_f32 v6, v71, v71
    v_and_b32 v71, 0xffff0000, v6
    v_sqrt_f32 v71, v71
    s_nop 0
    v_cvt_pk_bf16_f32 v6, v71, v71
    v_and_b32 v71, 0xffff0000, v6
    v_rcp_f32 v72, v71
    v_sub_f32 v76, v52, v70
    v_sub_f32 v77, v53, v70
    v_cvt_pk_bf16_f32 v6, v76, v77
    v_lshlrev_b32 v76, 16, v6
    v_and_b32 v77, 0xffff0000, v6
    v_mul_f32 v73, v76, v72
    v_mul_f32 v74, v77, v72
    v_fma_f32 v76, -v73, v71, v76
    v_fma_f32 v77, -v74, v71, v77
    v_fma_f32 v76, v76, v72, v73
    v_fma_f32 v77, v77, v72, v74
    v_cvt_pk_bf16_f32 v6, v76, v77
    v_lshlrev_b32 v76, 16, v6
    v_and_b32 v77, 0xffff0000, v6
    v_mul_f32 v76, v76, v50
    v_mul_f32 v77, v77, v51
    v_cvt_pk_bf16_f32 v6, v76, v77
    v_lshlrev_b32 v76, 16, v6
    v_and_b32 v77, 0xffff0000, v6
    v_add_f32 v76, v76, v48
    v_add_f32 v77, v77, v49
    v_cvt_pk_bf16_f32 v70, v76, v77
    ds_write_b32 v114, v70 offset:2048
    s_waitcnt lgkmcnt(0)
    ds_read_b128 v[28:31], v115 offset:2048
    ds_read_b128 v[32:35], v115 offset:2064
    s_waitcnt lgkmcnt(0)
    v_perm_b32 v16, v28, v28, v8
    v_perm_b32 v17, v28, v28, v9
    v_perm_b32 v18, v28, v28, v10
    v_perm_b32 v19, v28, v28, v11
    v_perm_b32 v20, v28, v28, v12
    v_perm_b32 v21, v28, v28, v13
    v_perm_b32 v22, v28, v28, v14
    v_perm_b32 v23, v28, v28, v15
    v_mfma_f32_16x16x32_bf16 v[24:27], v[16:19], a[192:195], 0
    v_perm_b32 v16, v29, v29, v8
    v_perm_b32 v17, v29, v29, v9
    v_perm_b32 v18, v29, v29, v10
    v_perm_b32 v19, v29, v29, v11
    v_mfma_f32_16x16x32_bf16 v[24:27], v[20:23], a[196:199], v[24:27]
    v_perm_b32 v20, v29, v29, v12
    v_perm_b32 v21, v29, v29, v13
    v_perm_b32 v22, v29, v29, v14
    v_perm_b32 v23, v29, v29, v15
    v_mfma_f32_16x16x32_bf16 v[24:27], v[16:19], a[200:203], v[24:27]
    v_perm_b32 v16, v30, v30, v8
    v_perm_b32 v17, v30, v30, v9
    v_perm_b32 v18, v30, v30, v10
    v_perm_b32 v19, v30, v30, v11
    v_mfma_f32_16x16x32_bf16 v[24:27], v[20:23], a[204:207], v[24:27]
    v_perm_b32 v20, v30, v30, v12
    v_perm_b32 v21, v30, v30, v13
    v_perm_b32 v22, v30, v30, v14
    v_perm_b32 v23, v30, v30, v15
    v_mfma_f32_16x16x32_bf16 v[24:27], v[16:19], a[208:211], v[24:27]
    v_perm_b32 v16, v31, v31, v8
    v_perm_b32 v17, v31, v31, v9
    v_perm_b32 v18, v31, v31, v10
    v_perm_b32 v19, v31, v31, v11
    v_mfma_f32_16x16x32_bf16 v[24:27], v[20:23], a[212:215], v[24:27]
    v_perm_b32 v20, v31, v31, v12
    v_perm_b32 v21, v31, v31, v13
    v_perm_b32 v22, v31, v31, v14
    v_perm_b32 v23, v31, v31, v15
    v_mfma_f32_16x16x32_bf16 v[24:27], v[16:19], a[216:219], v[24:27]
    v_perm_b32 v16, v32, v32, v8
    v_perm_b32 v17, v32, v32, v9
    v_perm_b32 v18, v32, v32, v10
    v_perm_b32 v19, v32, v32, v11
    v_mfma_f32_16x16x32_bf16 v[24:27], v[20:23], a[220:223], v[24:27]
    v_perm_b32 v20, v32, v32, v12
    v_perm_b32 v21, v32, v32, v13
    v_perm_b32 v22, v32, v32, v14
    v_perm_b32 v23, v32, v32, v15
    v_mfma_f32_16x16x32_bf16 v[24:27], v[16:19], a[224:227], v[24:27]
    v_perm_b32 v16, v33, v33, v8
    v_perm_b32 v17, v33, v33, v9
    v_perm_b32 v18, v33, v33, v10
    v_perm_b32 v19, v33, v33, v11
    v_mfma_f32_16x16x32_bf16 v[24:27], v[20:23], a[228:231], v[24:27]
    v_perm_b32 v20, v33, v33, v12
    v_perm_b32 v21, v33, v33, v13
    v_perm_b32 v22, v33, v33, v14
    v_perm_b32 v23, v33, v33, v15
    v_mfma_f32_16x16x32_bf16 v[24:27], v[16:19], a[232:235], v[24:27]
    v_perm_b32 v16, v34, v34, v8
    v_perm_b32 v17, v34, v34, v9
    v_perm_b32 v18, v34, v34, v10
    v_perm_b32 v19, v34, v34, v11
    v_mfma_f32_16x16x32_bf16 v[24:27], v[20:23], a[236:239], v[24:27]
    v_perm_b32 v20, v34, v34, v12
    v_perm_b32 v21, v34, v34, v13
    v_perm_b32 v22, v34, v34, v14
    v_perm_b32 v23, v34, v34, v15
    v_mfma_f32_16x16x32_bf16 v[24:27], v[16:19], a[240:243], v[24:27]
    v_perm_b32 v16, v35, v35, v8
    v_perm_b32 v17, v35, v35, v9
    v_perm_b32 v18, v35, v35, v10
    v_perm_b32 v19, v35, v35, v11
    v_mfma_f32_16x16x32_bf16 v[24:27], v[20:23], a[244:247], v[24:27]
    v_perm_b32 v20, v35, v35, v12
    v_perm_b32 v21, v35, v35, v13
    v_perm_b32 v22, v35, v35, v14
    v_perm_b32 v23, v35, v35, v15
    v_mfma_f32_16x16x32_bf16 v[24:27], v[16:19], a[248:251], v[24:27]
    s_nop 0
    v_mfma_f32_16x16x32_bf16 v[24:27], v[20:23], a[252:255], v[24:27]
    s_mov_b32 exec_lo, 0x00ff00ff
    s_mov_b32 exec_hi, 0xff00ff00
    s_nop 5
    ds_write_b128 v157, v[24:27] offset:10240
    s_mov_b64 exec, -1
    v_lshlrev_b32 v6, 2, v0
    s_waitcnt lgkmcnt(0)
    s_barrier
    ds_read_b32 v54, v6 offset:10240
    ds_read_b32 v55, v6 offset:10496
    ds_read_b32 v56, v6 offset:10752
    ds_read_b32 v57, v6 offset:11008
    ds_read_b32 v58, v6 offset:11264
    ds_read_b32 v59, v6 offset:11520
    ds_read_b32 v60, v6 offset:11776
    ds_read_b32 v61, v6 offset:12032
    s_lshl_b32 s8, s11, 15
    s_add_u32 s8, s8, 83968
    s_waitcnt lgkmcnt(0)
    v_pk_add_f32 v[54:55], v[54:55], v[56:57]
    v_pk_add_f32 v[58:59], v[58:59], v[60:61]
    v_pk_add_f32 v[54:55], v[54:55], v[58:59]
    v_add_f32 v54, v54, v55
    v_max_f32 v54, 0, v54
    v_cvt_pk_bf16_f32 v62, v54, v54
    s_nop 1
    v_and_b32_dpp v16, v62, v144 row_newbcast:0 row_mask:0xf bank_mask:0xf
    v_and_b32_dpp v17, v62, v145 row_newbcast:0 row_mask:0xf bank_mask:0xf
    v_and_b32_dpp v18, v62, v146 row_newbcast:0 row_mask:0xf bank_mask:0xf
    v_and_b32_dpp v19, v62, v147 row_newbcast:0 row_mask:0xf bank_mask:0xf
    v_and_b32_dpp v20, v62, v144 row_newbcast:1 row_mask:0xf bank_mask:0xf
    v_and_b32_dpp v21, v62, v145 row_newbcast:1 row_mask:0xf bank_mask:0xf
    v_and_b32_dpp v22, v62, v146 row_newbcast:1 row_mask:0xf bank_mask:0xf
    v_and_b32_dpp v23, v62, v147 row_newbcast:1 row_mask:0xf bank_mask:0xf
    v_mfma_f32_16x16x32_bf16 v[24:27], v[16:19], v[192:195], 0
    v_and_b32_dpp v16, v62, v144 row_newbcast:2 row_mask:0xf bank_mask:0xf
    v_and_b32_dpp v17, v62, v145 row_newbcast:2 row_mask:0xf bank_mask:0xf
    v_and_b32_dpp v18, v62, v146 row_newbcast:2 row_mask:0xf bank_mask:0xf
    v_and_b32_dpp v19, v62, v147 row_newbcast:2 row_mask:0xf bank_mask:0xf
    v_mfma_f32_16x16x32_bf16 v[24:27], v[20:23], v[196:199], v[24:27]
    v_and_b32_dpp v20, v62, v144 row_newbcast:3 row_mask:0xf bank_mask:0xf
    v_and_b32_dpp v21, v62, v145 row_newbcast:3 row_mask:0xf bank_mask:0xf
    v_and_b32_dpp v22, v62, v146 row_newbcast:3 row_mask:0xf bank_mask:0xf
    v_and_b32_dpp v23, v62, v147 row_newbcast:3 row_mask:0xf bank_mask:0xf
    v_mfma_f32_16x16x32_bf16 v[24:27], v[16:19], v[200:203], v[24:27]
    v_and_b32_dpp v16, v62, v144 row_newbcast:4 row_mask:0xf bank_mask:0xf
    v_and_b32_dpp v17, v62, v145 row_newbcast:4 row_mask:0xf bank_mask:0xf
    v_and_b32_dpp v18, v62, v146 row_newbcast:4 row_mask:0xf bank_mask:0xf
    v_and_b32_dpp v19, v62, v147 row_newbcast:4 row_mask:0xf bank_mask:0xf
    v_mfma_f32_16x16x32_bf16 v[24:27], v[20:23], v[204:207], v[24:27]
    v_and_b32_dpp v20, v62, v144 row_newbcast:5 row_mask:0xf bank_mask:0xf
    v_and_b32_dpp v21, v62, v145 row_newbcast:5 row_mask:0xf bank_mask:0xf
    v_and_b32_dpp v22, v62, v146 row_newbcast:5 row_mask:0xf bank_mask:0xf
    v_and_b32_dpp v23, v62, v147 row_newbcast:5 row_mask:0xf bank_mask:0xf
    v_mfma_f32_16x16x32_bf16 v[24:27], v[16:19], v[208:211], v[24:27]
    v_and_b32_dpp v16, v62, v144 row_newbcast:6 row_mask:0xf bank_mask:0xf
    v_and_b32_dpp v17, v62, v145 row_newbcast:6 row_mask:0xf bank_mask:0xf
    v_and_b32_dpp v18, v62, v146 row_newbcast:6 row_mask:0xf bank_mask:0xf
    v_and_b32_dpp v19, v62, v147 row_newbcast:6 row_mask:0xf bank_mask:0xf
    v_mfma_f32_16x16x32_bf16 v[24:27], v[20:23], v[212:215], v[24:27]
    v_and_b32_dpp v20, v62, v144 row_newbcast:7 row_mask:0xf bank_mask:0xf
    v_and_b32_dpp v21, v62, v145 row_newbcast:7 row_mask:0xf bank_mask:0xf
    v_and_b32_dpp v22, v62, v146 row_newbcast:7 row_mask:0xf bank_mask:0xf
    v_and_b32_dpp v23, v62, v147 row_newbcast:7 row_mask:0xf bank_mask:0xf
    v_mfma_f32_16x16x32_bf16 v[24:27], v[16:19], v[216:219], v[24:27]
    v_and_b32_dpp v16, v62, v144 row_newbcast:8 row_mask:0xf bank_mask:0xf
    v_and_b32_dpp v17, v62, v145 row_newbcast:8 row_mask:0xf bank_mask:0xf
    v_and_b32_dpp v18, v62, v146 row_newbcast:8 row_mask:0xf bank_mask:0xf
    v_and_b32_dpp v19, v62, v147 row_newbcast:8 row_mask:0xf bank_mask:0xf
    v_mfma_f32_16x16x32_bf16 v[24:27], v[20:23], v[220:223], v[24:27]
    v_and_b32_dpp v20, v62, v144 row_newbcast:9 row_mask:0xf bank_mask:0xf
    v_and_b32_dpp v21, v62, v145 row_newbcast:9 row_mask:0xf bank_mask:0xf
    v_and_b32_dpp v22, v62, v146 row_newbcast:9 row_mask:0xf bank_mask:0xf
    v_and_b32_dpp v23, v62, v147 row_newbcast:9 row_mask:0xf bank_mask:0xf
    v_mfma_f32_16x16x32_bf16 v[24:27], v[16:19], v[224:227], v[24:27]
    v_and_b32_dpp v16, v62, v144 row_newbcast:10 row_mask:0xf bank_mask:0xf
    v_and_b32_dpp v17, v62, v145 row_newbcast:10 row_mask:0xf bank_mask:0xf
    v_and_b32_dpp v18, v62, v146 row_newbcast:10 row_mask:0xf bank_mask:0xf
    v_and_b32_dpp v19, v62, v147 row_newbcast:10 row_mask:0xf bank_mask:0xf
    v_mfma_f32_16x16x32_bf16 v[24:27], v[20:23], v[228:231], v[24:27]
    v_and_b32_dpp v20, v62, v144 row_newbcast:11 row_mask:0xf bank_mask:0xf
    v_and_b32_dpp v21, v62, v145 row_newbcast:11 row_mask:0xf bank_mask:0xf
    v_and_b32_dpp v22, v62, v146 row_newbcast:11 row_mask:0xf bank_mask:0xf
    v_and_b32_dpp v23, v62, v147 row_newbcast:11 row_mask:0xf bank_mask:0xf
    v_mfma_f32_16x16x32_bf16 v[24:27], v[16:19], v[232:235], v[24:27]
    v_and_b32_dpp v16, v62, v144 row_newbcast:12 row_mask:0xf bank_mask:0xf
    v_and_b32_dpp v17, v62, v145 row_newbcast:12 row_mask:0xf bank_mask:0xf
    v_and_b32_dpp v18, v62, v146 row_newbcast:12 row_mask:0xf bank_mask:0xf
    v_and_b32_dpp v19, v62, v147 row_newbcast:12 row_mask:0xf bank_mask:0xf
    v_mfma_f32_16x16x32_bf16 v[24:27], v[20:23], v[236:239], v[24:27]
    v_and_b32_dpp v20, v62, v144 row_newbcast:13 row_mask:0xf bank_mask:0xf
    v_and_b32_dpp v21, v62, v145 row_newbcast:13 row_mask:0xf bank_mask:0xf
    v_and_b32_dpp v22, v62, v146 row_newbcast:13 row_mask:0xf bank_mask:0xf
    v_and_b32_dpp v23, v62, v147 row_newbcast:13 row_mask:0xf bank_mask:0xf
    v_mfma_f32_16x16x32_bf16 v[24:27], v[16:19], v[240:243], v[24:27]
    v_and_b32_dpp v16, v62, v144 row_newbcast:14 row_mask:0xf bank_mask:0xf
    v_and_b32_dpp v17, v62, v145 row_newbcast:14 row_mask:0xf bank_mask:0xf
    v_and_b32_dpp v18, v62, v146 row_newbcast:14 row_mask:0xf bank_mask:0xf
    v_and_b32_dpp v19, v62, v147 row_newbcast:14 row_mask:0xf bank_mask:0xf
    v_mfma_f32_16x16x32_bf16 v[24:27], v[20:23], v[244:247], v[24:27]
    v_and_b32_dpp v20, v62, v144 row_newbcast:15 row_mask:0xf bank_mask:0xf
    v_and_b32_dpp v21, v62, v145 row_newbcast:15 row_mask:0xf bank_mask:0xf
    v_and_b32_dpp v22, v62, v146 row_newbcast:15 row_mask:0xf bank_mask:0xf
    v_and_b32_dpp v23, v62, v147 row_newbcast:15 row_mask:0xf bank_mask:0xf
    v_mfma_f32_16x16x32_bf16 v[24:27], v[16:19], v[248:251], v[24:27]
    s_nop 0
    v_mfma_f32_16x16x32_bf16 v[24:27], v[20:23], v[252:255], v[24:27]
    s_nop 7
    v_cvt_pk_bf16_f32 v54, v24, v25
    v_cvt_pk_bf16_f32 v55, v26, v27
    s_mov_b32 exec_hi, 0
    s_cmp_eq_u32 s13, 1
    s_cbranch_scc0 L_slow_23
    buffer_store_dwordx2 v[54:55], v188, s[52:55], s8 offen
    s_branch L_pub_24
L_slow_23:
    buffer_store_dwordx2 v[54:55], v188, s[52:55], s8 offen sc1
L_pub_24:
    s_mov_b64 exec, -1
    s_branch L_fin
L_final:
    s_cmp_lg_u32 s3, 0
    s_cbranch_scc1 L_ep_25
    v_add_u32 v6, 1, v4
    v_mov_b32 v7, 0
    s_mov_b64 exec, 1
    buffer_store_dword v6, v7, s[52:55], 0 offen sc1
    s_mov_b64 exec, -1
L_ep_25:
    v_mov_b32 v100, 0
    v_mov_b32 v101, 0
    v_mov_b32 v102, 0
    v_mov_b32 v103, 0
    s_mov_b32 s43, 0
L_t5:
    s_mov_b32 s8, 83968
    buffer_load_dwordx4 v[80:83], v183, s[52:55], s8 offen sc1
    s_mov_b32 s8, 215040
    buffer_load_dwordx4 v[84:87], v183, s[52:55], s8 offen sc1
    s_mov_b32 s8, 346112
    buffer_load_dwordx4 v[88:91], v183, s[52:55], s8 offen sc1
    s_mov_b32 s8, 477184
    buffer_load_dwordx4 v[92:95], v183, s[52:55], s8 offen sc1
    s_mov_b32 s8, 608256
    buffer_load_dwordx4 v[96:99], v183, s[52:55], s8 offen sc1
    s_mov_b32 exec_hi, 0
    s_mov_b32 s8, 739328
    buffer_load_dwordx4 v[100:103], v183, s[52:55], s8 offen sc1
    s_mov_b64 exec, -1
    s_waitcnt vmcnt(5)
    v_mfma_f32_16x16x32_bf16 v[24:27], v[184:187], v[80:83], 0
    s_waitcnt vmcnt(4)
    v_mfma_f32_16x16x32_bf16 v[24:27], v[184:187], v[84:87], v[24:27]
    s_waitcnt vmcnt(3)
    v_mfma_f32_16x16x32_bf16 v[24:27], v[184:187], v[88:91], v[24:27]
    s_waitcnt vmcnt(2)
    v_mfma_f32_16x16x32_bf16 v[24:27], v[184:187], v[92:95], v[24:27]
    s_waitcnt vmcnt(1)
    v_mfma_f32_16x16x32_bf16 v[24:27], v[184:187], v[96:99], v[24:27]
    s_waitcnt vmcnt(0)
    v_mfma_f32_16x16x32_bf16 v[24:27], v[184:187], v[100:103], v[24:27]
    s_nop 7
    v_pk_add_f32 v[54:55], v[24:25], v[26:27]
    v_cmp_u_f32 vcc, v54, v55
    s_cbranch_vccz L_t5_ok
    s_add_u32 s43, s43, 1
    s_cmp_le_u32 s43, s42
    s_nop 1
    s_cbranch_scc1 L_t5
L_t5_ok:
    v_permlane32_swap_b32 v24, v26
    v_permlane32_swap_b32 v25, v27
    v_cvt_pk_bf16_f32 v6, v24, v25
    v_lshlrev_b32 v24, 16, v6
    v_and_b32 v25, 0xffff0000, v6
    v_pk_mul_f32 v[24:25], v[160:161], v[24:25]
    v_cvt_pk_bf16_f32 v6, v24, v25
    v_lshlrev_b32 v24, 16, v6
    v_and_b32 v25, 0xffff0000, v6
    v_pk_add_f32 v[24:25], v[52:53], v[24:25]
    v_cvt_pk_bf16_f32 v54, v24, v25
    buffer_store_dword v54, v5, s[96:99], 0 offen
L_fin:
    s_endpgm
L_exit:
    s_endpgm

.section .rodata,"a"
.p2align 6
.amdhsa_kernel adaLN_cond__gqa_block_cached__dense_activation_relu__decode_kernel
  .amdhsa_next_free_vgpr 512
  .amdhsa_next_free_sgpr 102
  .amdhsa_accum_offset 256
  .amdhsa_group_segment_fixed_size 0
  .amdhsa_kernarg_size 104
  .amdhsa_user_sgpr_count 2
  .amdhsa_user_sgpr_kernarg_segment_ptr 1
  .amdhsa_system_sgpr_workgroup_id_x 1
.end_amdhsa_kernel
```
